```python
import torch

def _softmax(x, axis=-1):
    return torch.softmax(x, dim=axis)

def _gelu(x):
    return torch.nn.functional.gelu(x, approximate='tanh')

def _silu(x):
    return torch.nn.functional.silu(x)

def _sigmoid(x):
    return torch.sigmoid(x)

def _layernorm(x, axis=-1, eps=1e-05):
    m = x.mean(dim=axis, keepdim=True)
    v = x.var(dim=axis, keepdim=True, unbiased=False)
    return (x - m) / torch.sqrt(v + eps)

def _scatter_add(tgt, idx, src, axis=0):
    return tgt.clone().index_add_(axis, idx, src)

def _segment_sum(src, seg, n):
    out = torch.zeros((n,) + src.shape[1:], dtype=src.dtype)
    return out.index_add_(0, seg, src)

def _pad(x, pw):
    flat = tuple((v for pair in reversed(pw) for v in pair))
    return torch.nn.functional.pad(x, flat)
kernel_name = 'standalone__autoregressive_conv_wavernn__speech'

def setup_inputs():

    _w = lambda a: (lambda t: t.to(torch.bfloat16) if t.is_floating_point() else t)(torch.as_tensor(a))
    B, T, D, K = (2, 1000, 256, 31)
    return {'x': _w((lambda *s: torch.randn(*s, dtype=torch.bfloat16) * 0.05)(B, T, D)), 'w': _w((lambda *s: torch.randn(*s, dtype=torch.bfloat16) * 0.05)(K, D, 2 * D))}

def reference(x, w):
    B, T, D = x.shape
    K = w.shape[0]
    dil = 2
    pad = (K - 1) * dil
    xp = _pad(x, ((0, 0), (pad, 0), (0, 0)))
    h = torch.einsum('btd,de->bte', xp[:, 0:T, :], w[0])
    for i in range(1, K):
        h = h + torch.einsum('btd,de->bte', xp[:, i * dil:i * dil + T, :], w[i])
    f, g = (h[..., :D].clone(), h[..., D:].clone())
    return torch.tanh(f) * _sigmoid(g)
```

```asm
; @launch grid=(256,1,1) block=(512,1,1) lds=163584
.amdgcn_target "amdgcn-amd-amdhsa--gfx950"
.text
.globl standalone__autoregressive_conv_wavernn__speech_kernel
.p2align 12
.p2align 8
.type standalone__autoregressive_conv_wavernn__speech_kernel,@function
standalone__autoregressive_conv_wavernn__speech_kernel:
    s_cmp_ge_u32 s2, 256
    s_cbranch_scc1 L_end
    s_getpc_b64 s[96:97]
L_pc0:
    s_load_dwordx4 s[4:7], s[0:1], 0
    s_load_dwordx4 s[8:11], s[0:1], 16
    s_load_dwordx2 s[12:13], s[0:1], 32
    v_lshrrev_b32 v238, 4, v0
    s_bfe_u32 s45, s2, 0x30003
    v_lshl_add_u32 v238, v238, 3, s45
    v_lshlrev_b32 v238, 7, v238
    v_min_u32 v238, L_codeend-L_pc0-4, v238
    global_load_dword v251, v238, s[96:97]
    v_lshrrev_b32 v237, 6, v0
    v_and_b32 v232, 63, v0
    v_readfirstlane_b32 s36, v237
    s_and_b32 s45, s2, 7
    s_lshr_b32 s46, s2, 3
    s_and_b32 s38, s45, 3
    s_lshr_b32 s39, s45, 2
    s_and_b32 s37, s46, 7
    s_lshr_b32 s47, s46, 3
    s_and_b32 s41, s47, 1
    s_lshr_b32 s40, s47, 1
    s_lshr_b32 s42, s37, 1
    s_and_b32 s43, s37, 1
    v_lshrrev_b32 v237, 3, v232
    v_and_b32 v238, 7, v232
    s_mul_i32 s54, s39, 512000
    s_mov_b32 s55, 0xffff0000
    s_and_b32 s45, s36, 6
    s_cmp_eq_u32 s45, 6
    s_cbranch_scc0 L_notloader
    s_sub_u32 s57, s36, 6
    s_lshl_b32 s48, s42, 16
    s_lshl_b32 s46, s38, 7
    s_add_u32 s48, s48, s46
    s_lshl_b32 s46, s57, 9
    s_add_u32 s47, s48, s46
    s_lshl_b32 s46, s43, 9
    s_add_u32 s48, s48, s46
    s_sub_u32 s22, 8126464, s48
    s_mov_b32 s23, 0x20000
    s_sub_u32 s62, 8126464, s47
    s_mov_b32 s63, 0x20000
    v_lshrrev_b32 v239, 1, v238
    v_bfe_u32 v240, v237, 1, 1
    v_xor_b32 v239, v239, v240
    v_and_b32 v240, 1, v238
    v_lshlrev_b32 v248, 10, v237
    v_lshl_add_u32 v248, v240, 4, v248
    s_lshl_b32 s46, s57, 1
    v_xor_b32 v240, s46, v239
    v_lshl_add_u32 v248, v240, 5, v248
    s_lshl_b32 s45, s57, 13
    v_add_u32 v248, s45, v248
    v_add_u32 v249, 14336, v248
    s_lshl_b32 s52, s57, 10
    s_lshl_b32 s45, s40, 1
    s_or_b32 s45, s45, s41
    s_lshl_b32 s45, s45, 1
    s_or_b32 s45, s45, s43
    s_lshl_b32 s45, s45, 12
    v_and_b32 v11, 3, v232
    v_lshlrev_b32 v11, 10, v11
    v_add_u32 v11, s45, v11
    v_lshrrev_b32 v10, 2, v232
    s_lshr_b32 s45, s2, 3
    s_lshl_b32 s45, s45, 14
    s_lshl_b32 s46, s57, 9
    s_add_u32 s45, s45, s46
    s_add_u32 s45, s45, 384
    v_lshlrev_b32 v16, 10, v232
    v_add_u32 v16, s45, v16
    s_mov_b32 s18, 512000
    s_mov_b32 s19, 0x20000
    s_waitcnt lgkmcnt(0)
    s_add_u32 s20, s6, s48
    s_addc_u32 s21, s7, 0
    s_add_u32 s60, s6, s47
    s_addc_u32 s61, s7, 0
    v_lshlrev_b32 v13, 20, v232
    s_mov_b64 exec, 0xff
    buffer_load_dword v15, v13, s[60:63], 0 offen
    s_mov_b64 exec, -1
    s_add_u32 s16, s4, s54
    s_addc_u32 s17, s5, 0
    s_mov_b64 exec, 0xffff
    buffer_load_dword v15, v16, s[16:19], 0 offen
    s_mov_b64 exec, -1
    s_add_u32 m0, s52, 57088
    s_mov_b32 s51, 0
    buffer_load_dwordx4 v248, s[20:23], s51 offen lds
    buffer_load_dwordx4 v249, s[20:23], s51 offen offset:2048 lds
    s_add_u32 m0, s52, 61184
    s_mov_b32 s51, 262144
    buffer_load_dwordx4 v248, s[20:23], s51 offen lds
    buffer_load_dwordx4 v249, s[20:23], s51 offen offset:2048 lds
    s_add_u32 m0, s52, 65280
    s_mov_b32 s51, 524288
    buffer_load_dwordx4 v248, s[20:23], s51 offen lds
    buffer_load_dwordx4 v249, s[20:23], s51 offen offset:2048 lds
    s_add_u32 m0, s52, 69376
    s_mov_b32 s51, 786432
    buffer_load_dwordx4 v248, s[20:23], s51 offen lds
    buffer_load_dwordx4 v249, s[20:23], s51 offen offset:2048 lds
    v_add_u32 v10, 4, v10
    v_and_b32 v12, 31, v10
    v_lshl_add_u32 v12, v12, 18, v11
    v_lshrrev_b32 v14, 5, v10
    v_lshl_add_u32 v12, v14, 15, v12
    buffer_load_dword v15, v12, s[60:63], 0 offen
    v_add_u32 v10, 16, v10
    s_branch L_lrest
L_notloader:
    s_mov_b32 s47, s36
    s_lshl_b32 s47, s47, 3
    v_add_u32 v239, s47, v237
    v_mul_u32_u24 v0, 6144, v239
    v_lshl_add_u32 v0, v238, 4, v0
    s_lshl_b32 s45, s41, 18
    s_sub_u32 s45, s45, 30720
    s_lshl_b32 s46, s40, 9
    s_add_u32 s45, s45, s46
    s_lshl_b32 s46, s42, 7
    s_add_u32 s45, s45, s46
    s_mul_i32 s46, s43, 6144
    s_add_u32 s45, s45, s46
    s_lshl_b32 s46, s43, 11
    s_sub_u32 s46, 1024, s46
    v_add_u32 v0, s45, v0
    v_add_u32 v1, s46, v0
    v_add_u32 v2, s46, v1
    v_add_u32 v3, s46, v2
    v_add_u32 v4, s46, v3
    v_add_u32 v5, s46, v4
    v_add_u32 v6, s46, v5
    s_mov_b32 s18, 512000
    s_mov_b32 s19, 0x20000
    s_waitcnt lgkmcnt(0)
    s_add_u32 s16, s4, s54
    s_addc_u32 s17, s5, 0
    buffer_load_dwordx4 v[8:11], v0, s[16:19], 0 offen
    buffer_load_dwordx4 v[12:15], v1, s[16:19], 0 offen
    buffer_load_dwordx4 v[16:19], v2, s[16:19], 0 offen
    buffer_load_dwordx4 v[20:23], v3, s[16:19], 0 offen
    buffer_load_dwordx4 v[24:27], v4, s[16:19], 0 offen
    buffer_load_dwordx4 v[28:31], v5, s[16:19], 0 offen
    buffer_load_dwordx4 v[32:35], v6, s[16:19], 0 offen
    v_mul_u32_u24 v240, 3, v239
    s_lshl_b32 s45, s43, 1
    v_add_u32 v240, s45, v240
    s_sub_u32 s45, 1, s45
    s_mul_i32 s46, s43, 19008
    s_sub_u32 s47, 19008, s46
    v_lshrrev_b32 v36, 3, v240
    v_lshlrev_b32 v36, 5, v36
    v_lshl_add_u32 v36, v240, 7, v36
    v_lshl_add_u32 v36, v238, 4, v36
    v_add_u32 v136, s46, v36
    v_add_u32 v140, s47, v36
    v_add_u32 v240, s45, v240
    v_lshrrev_b32 v37, 3, v240
    v_lshlrev_b32 v37, 5, v37
    v_lshl_add_u32 v37, v240, 7, v37
    v_lshl_add_u32 v37, v238, 4, v37
    v_add_u32 v137, s46, v37
    v_add_u32 v141, s47, v37
    v_add_u32 v240, s45, v240
    v_lshrrev_b32 v38, 3, v240
    v_lshlrev_b32 v38, 5, v38
    v_lshl_add_u32 v38, v240, 7, v38
    v_lshl_add_u32 v38, v238, 4, v38
    v_add_u32 v138, s46, v38
    v_add_u32 v142, s47, v38
    s_mov_b32 s28, s12
    s_mov_b32 s29, s13
    s_mov_b32 s30, 8650752
    s_mov_b32 s31, 0x20000
    s_mov_b32 s24, s8
    s_mov_b32 s25, s9
    s_mov_b32 s26, 1024000
    s_mov_b32 s27, 0x20000
    v_lshrrev_b32 v237, 4, v232
    v_bfe_u32 v238, v232, 2, 2
    v_lshl_add_u32 v239, v237, 3, v238
    v_lshlrev_b32 v233, 7, v239
    v_lshrrev_b32 v238, 1, v238
    v_and_b32 v239, 1, v237
    v_lshl_add_u32 v238, v239, 1, v238
    v_xor_b32 v238, s36, v238
    v_lshl_add_u32 v233, v238, 5, v233
    v_and_b32 v238, 3, v232
    v_lshl_add_u32 v233, v238, 3, v233
    v_add_u32 v233, 57088, v233
    v_add_u32 v234, 57344, v233
    v_and_b32 v238, 15, v232
    v_mul_u32_u24 v235, 1056, v238
    v_lshl_add_u32 v235, v237, 4, v235
    s_lshl_b32 s44, s39, 1
    s_or_b32 s44, s44, s40
    s_lshl_b32 s44, s44, 1
    s_or_b32 s44, s44, s41
    s_lshl_b32 s44, s44, 2
    s_or_b32 s44, s44, s38
    s_and_b32 s48, s36, 3
    s_lshr_b32 s47, s36, 2
    s_lshl_b32 s45, s44, 3
    s_add_u32 s45, s45, s37
    s_lshl_b32 s46, s45, 15
    v_and_b32 v243, 31, v232
    v_lshlrev_b32 v243, 4, v243
    v_lshrrev_b32 v237, 5, v232
    v_lshl_add_u32 v243, v237, 12, v243
    v_add_u32 v243, s46, v243
    s_lshl_b32 s46, s48, 1
    s_add_u32 s46, s46, s47
    s_lshl_b32 s46, s46, 9
    v_add_u32 v243, s46, v243
    s_lshl_b32 s45, s45, 10
    s_add_u32 s45, s45, 8388608
    v_and_b32 v246, 7, v232
    v_lshlrev_b32 v246, 2, v246
    v_add_u32 v246, s45, v246
    s_lshl_b32 s46, s48, 5
    s_add_u32 s46, s46, 512
    v_add_u32 v236, s46, v246
    s_lshl_b32 s46, s48, 7
    v_add_u32 v246, s46, v246
    v_and_b32 v237, 8, v232
    v_cmp_ne_u32 s[58:59], 0, v237
    v_mov_b32 v245, 57024
    s_nop 0
    v_cndmask_b32 v246, v246, v236, s[58:59]
    v_and_b32 v237, 15, v232
    v_bfe_u32 v238, v232, 4, 1
    s_lshl_b32 s45, s41, 7
    s_add_u32 s45, s45, s37
    v_lshl_add_u32 v239, v237, 3, s45
    v_lshlrev_b32 v242, 11, v239
    v_lshrrev_b32 v240, 5, v232
    v_lshl_add_u32 v242, v240, 10, v242
    v_lshl_add_u32 v242, v238, 3, v242
    s_lshl_b32 s45, s40, 9
    s_add_u32 s45, s45, s54
    s_lshl_b32 s46, s38, 7
    s_add_u32 s45, s45, s46
    s_lshl_b32 s46, s48, 5
    s_add_u32 s45, s45, s46
    s_lshl_b32 s46, s47, 4
    s_add_u32 s45, s45, s46
    v_add_u32 v242, s45, v242
    v_mov_b32 v237, 0x7ffff000
    s_movk_i32 s46, 250
    v_cmp_gt_u32 s[58:59], s46, v239
    s_mov_b32 s80, 0
    s_mov_b32 s82, 8192
    s_mov_b32 s84, 16384
    s_mov_b32 s86, 24576
    v_cndmask_b32 v242, v237, v242, s[58:59]
    v_lshrrev_b32 v238, 5, v232
    v_cmp_eq_u32 s[58:59], s43, v238
    v_and_b32 v253, 31, v232
    v_lshlrev_b32 v253, 4, v253
    s_lshl_b32 s45, s48, 11
    s_lshl_b32 s46, s47, 9
    s_add_u32 s45, s45, s46
    s_add_u32 s45, s45, 81664
    v_add_u32 v253, s45, v253
    v_cndmask_b32 v252, v243, v237, s[58:59]
    v_cndmask_b32 v253, v237, v253, s[58:59]
    s_add_u32 s45, s42, 1
    s_and_b32 s45, s45, 3
    s_lshl_b32 s80, s45, 13
    s_add_u32 s45, s42, 2
    s_and_b32 s45, s45, 3
    s_lshl_b32 s82, s45, 13
    s_add_u32 s45, s42, 3
    s_and_b32 s45, s45, 3
    s_lshl_b32 s84, s45, 13
    s_add_u32 s45, s42, 4
    s_and_b32 s45, s45, 3
    s_lshl_b32 s86, s45, 13
    s_lshl_b32 s45, s44, 18
    s_lshl_b32 s47, s36, 10
    s_add_u32 s45, s45, s47
    s_lshl_b32 s47, s37, 12
    s_add_u32 s45, s45, s47
    v_lshlrev_b32 v241, 4, v232
    v_add_u32 v241, s45, v241
    s_lshl_b32 s45, s44, 13
    s_lshl_b32 s47, s37, 2
    s_add_u32 s45, s45, s47
    s_add_u32 s45, s45, 8388608
    v_and_b32 v247, 7, v232
    v_lshlrev_b32 v247, 10, v247
    v_add_u32 v247, s45, v247
    s_and_b32 s47, s36, 3
    s_lshl_b32 s56, s47, 7
    s_lshl_b32 s49, s47, 5
    s_add_u32 s49, s49, 512
    s_cmp_eq_u32 s37, 0
    s_cselect_b32 s88, 0x4000000, 0
    s_cmp_eq_u32 s37, 1
    s_cselect_b32 s89, 0x4000000, 0
    s_add_u32 s89, s89, 32768
    s_cmp_eq_u32 s37, 2
    s_cselect_b32 s90, 0x4000000, 0
    s_add_u32 s90, s90, 65536
    s_cmp_eq_u32 s37, 3
    s_cselect_b32 s91, 0x4000000, 0
    s_add_u32 s91, s91, 98304
    s_cmp_eq_u32 s37, 4
    s_cselect_b32 s92, 0x4000000, 0
    s_add_u32 s92, s92, 131072
    s_cmp_eq_u32 s37, 5
    s_cselect_b32 s93, 0x4000000, 0
    s_add_u32 s93, s93, 163840
    s_cmp_eq_u32 s37, 6
    s_cselect_b32 s94, 0x4000000, 0
    s_add_u32 s94, s94, 196608
    s_cmp_eq_u32 s37, 7
    s_cselect_b32 s95, 0x4000000, 0
    s_add_u32 s95, s95, 229376
    s_waitcnt vmcnt(6)
    v_lshlrev_b32 v40, 16, v8
    v_and_b32 v41, s55, v8
    v_lshlrev_b32 v42, 16, v9
    v_and_b32 v43, s55, v9
    v_lshlrev_b32 v44, 16, v10
    v_and_b32 v45, s55, v10
    v_lshlrev_b32 v46, 16, v11
    v_and_b32 v47, s55, v11
    s_waitcnt vmcnt(5)
    ds_write_b128 v36, v[12:15] offset:38016
    v_lshlrev_b32 v48, 16, v12
    v_and_b32 v49, s55, v12
    v_lshlrev_b32 v50, 16, v13
    v_and_b32 v51, s55, v13
    v_lshlrev_b32 v52, 16, v14
    v_and_b32 v53, s55, v14
    v_lshlrev_b32 v54, 16, v15
    v_and_b32 v55, s55, v15
    v_pk_add_f32 v[96:97], v[40:41], v[48:49] neg_lo:[0,1] neg_hi:[0,1]
    v_pk_add_f32 v[98:99], v[42:43], v[50:51] neg_lo:[0,1] neg_hi:[0,1]
    v_pk_add_f32 v[100:101], v[44:45], v[52:53] neg_lo:[0,1] neg_hi:[0,1]
    v_pk_add_f32 v[102:103], v[46:47], v[54:55] neg_lo:[0,1] neg_hi:[0,1]
    v_cvt_pk_bf16_f32 v112, v96, v97
    v_cvt_pk_bf16_f32 v113, v98, v99
    v_cvt_pk_bf16_f32 v114, v100, v101
    v_cvt_pk_bf16_f32 v115, v102, v103
    ds_write_b128 v136, v[112:115]
    s_waitcnt vmcnt(4)
    v_lshlrev_b32 v56, 16, v16
    v_and_b32 v57, s55, v16
    v_lshlrev_b32 v58, 16, v17
    v_and_b32 v59, s55, v17
    v_lshlrev_b32 v60, 16, v18
    v_and_b32 v61, s55, v18
    v_lshlrev_b32 v62, 16, v19
    v_and_b32 v63, s55, v19
    v_pk_add_f32 v[104:105], v[56:57], v[48:49] neg_lo:[0,1] neg_hi:[0,1]
    v_pk_add_f32 v[106:107], v[58:59], v[50:51] neg_lo:[0,1] neg_hi:[0,1]
    v_pk_add_f32 v[108:109], v[60:61], v[52:53] neg_lo:[0,1] neg_hi:[0,1]
    v_pk_add_f32 v[110:111], v[62:63], v[54:55] neg_lo:[0,1] neg_hi:[0,1]
    v_cvt_pk_bf16_f32 v116, v104, v105
    v_cvt_pk_bf16_f32 v117, v106, v107
    v_cvt_pk_bf16_f32 v118, v108, v109
    v_cvt_pk_bf16_f32 v119, v110, v111
    ds_write_b128 v140, v[116:119]
    s_waitcnt vmcnt(3)
    ds_write_b128 v37, v[20:23] offset:38016
    v_lshlrev_b32 v64, 16, v20
    v_and_b32 v65, s55, v20
    v_lshlrev_b32 v66, 16, v21
    v_and_b32 v67, s55, v21
    v_lshlrev_b32 v68, 16, v22
    v_and_b32 v69, s55, v22
    v_lshlrev_b32 v70, 16, v23
    v_and_b32 v71, s55, v23
    v_pk_add_f32 v[96:97], v[56:57], v[64:65] neg_lo:[0,1] neg_hi:[0,1]
    v_pk_add_f32 v[98:99], v[58:59], v[66:67] neg_lo:[0,1] neg_hi:[0,1]
    v_pk_add_f32 v[100:101], v[60:61], v[68:69] neg_lo:[0,1] neg_hi:[0,1]
    v_pk_add_f32 v[102:103], v[62:63], v[70:71] neg_lo:[0,1] neg_hi:[0,1]
    v_cvt_pk_bf16_f32 v120, v96, v97
    v_cvt_pk_bf16_f32 v121, v98, v99
    v_cvt_pk_bf16_f32 v122, v100, v101
    v_cvt_pk_bf16_f32 v123, v102, v103
    ds_write_b128 v137, v[120:123]
    s_waitcnt vmcnt(2)
    v_lshlrev_b32 v72, 16, v24
    v_and_b32 v73, s55, v24
    v_lshlrev_b32 v74, 16, v25
    v_and_b32 v75, s55, v25
    v_lshlrev_b32 v76, 16, v26
    v_and_b32 v77, s55, v26
    v_lshlrev_b32 v78, 16, v27
    v_and_b32 v79, s55, v27
    v_pk_add_f32 v[104:105], v[72:73], v[64:65] neg_lo:[0,1] neg_hi:[0,1]
    v_pk_add_f32 v[106:107], v[74:75], v[66:67] neg_lo:[0,1] neg_hi:[0,1]
    v_pk_add_f32 v[108:109], v[76:77], v[68:69] neg_lo:[0,1] neg_hi:[0,1]
    v_pk_add_f32 v[110:111], v[78:79], v[70:71] neg_lo:[0,1] neg_hi:[0,1]
    v_cvt_pk_bf16_f32 v124, v104, v105
    v_cvt_pk_bf16_f32 v125, v106, v107
    v_cvt_pk_bf16_f32 v126, v108, v109
    v_cvt_pk_bf16_f32 v127, v110, v111
    ds_write_b128 v141, v[124:127]
    s_waitcnt vmcnt(1)
    ds_write_b128 v38, v[28:31] offset:38016
    v_lshlrev_b32 v80, 16, v28
    v_and_b32 v81, s55, v28
    v_lshlrev_b32 v82, 16, v29
    v_and_b32 v83, s55, v29
    v_lshlrev_b32 v84, 16, v30
    v_and_b32 v85, s55, v30
    v_lshlrev_b32 v86, 16, v31
    v_and_b32 v87, s55, v31
    v_pk_add_f32 v[96:97], v[72:73], v[80:81] neg_lo:[0,1] neg_hi:[0,1]
    v_pk_add_f32 v[98:99], v[74:75], v[82:83] neg_lo:[0,1] neg_hi:[0,1]
    v_pk_add_f32 v[100:101], v[76:77], v[84:85] neg_lo:[0,1] neg_hi:[0,1]
    v_pk_add_f32 v[102:103], v[78:79], v[86:87] neg_lo:[0,1] neg_hi:[0,1]
    v_cvt_pk_bf16_f32 v128, v96, v97
    v_cvt_pk_bf16_f32 v129, v98, v99
    v_cvt_pk_bf16_f32 v130, v100, v101
    v_cvt_pk_bf16_f32 v131, v102, v103
    ds_write_b128 v138, v[128:131]
    s_waitcnt vmcnt(0)
    v_lshlrev_b32 v88, 16, v32
    v_and_b32 v89, s55, v32
    v_lshlrev_b32 v90, 16, v33
    v_and_b32 v91, s55, v33
    v_lshlrev_b32 v92, 16, v34
    v_and_b32 v93, s55, v34
    v_lshlrev_b32 v94, 16, v35
    v_and_b32 v95, s55, v35
    v_pk_add_f32 v[104:105], v[88:89], v[80:81] neg_lo:[0,1] neg_hi:[0,1]
    v_pk_add_f32 v[106:107], v[90:91], v[82:83] neg_lo:[0,1] neg_hi:[0,1]
    v_pk_add_f32 v[108:109], v[92:93], v[84:85] neg_lo:[0,1] neg_hi:[0,1]
    v_pk_add_f32 v[110:111], v[94:95], v[86:87] neg_lo:[0,1] neg_hi:[0,1]
    v_cvt_pk_bf16_f32 v132, v104, v105
    v_cvt_pk_bf16_f32 v133, v106, v107
    v_cvt_pk_bf16_f32 v134, v108, v109
    v_cvt_pk_bf16_f32 v135, v110, v111
    ds_write_b128 v142, v[132:135]
    s_cmp_ge_u32 s36, 4
    s_cbranch_scc1 L_helper2
    s_setprio 1
    s_waitcnt lgkmcnt(0)
    s_barrier
    ds_read_b64_tr_b16 v[192:193], v233 offset:0
    ds_read_b64_tr_b16 v[194:195], v233 offset:512
    ds_read_b128 v[96:99], v235 offset:0
    ds_read_b128 v[100:103], v235 offset:128
    ds_read_b128 v[104:107], v235 offset:256
    ds_read_b128 v[108:111], v235 offset:384
    ds_read_b128 v[112:115], v235 offset:512
    ds_read_b128 v[116:119], v235 offset:640
    ds_read_b128 v[120:123], v235 offset:768
    ds_read_b64_tr_b16 v[200:201], v233 offset:8192
    ds_read_b128 v[124:127], v235 offset:896
    ds_read_b64_tr_b16 v[196:197], v233 offset:4096
    ds_read_b64_tr_b16 v[202:203], v233 offset:8704
    ds_read_b64_tr_b16 v[198:199], v233 offset:4608
    s_mov_b64 vcc, 0
    s_waitcnt lgkmcnt(11)
    v_mfma_f32_16x16x32_bf16 v[0:3], v[192:195], v[96:99], 0
    s_waitcnt lgkmcnt(10)
    ds_read_b64_tr_b16 v[204:205], v233 offset:12288
    v_mfma_f32_16x16x32_bf16 v[4:7], v[192:195], v[100:103], 0
    s_waitcnt lgkmcnt(10)
    ds_read_b64_tr_b16 v[206:207], v233 offset:12800
    v_mfma_f32_16x16x32_bf16 v[8:11], v[192:195], v[104:107], 0
    s_waitcnt lgkmcnt(10)
    ds_read_b128 v[96:99], v235 offset:1056
    v_mfma_f32_16x16x32_bf16 v[12:15], v[192:195], v[108:111], 0
    s_waitcnt lgkmcnt(10)
    ds_read_b128 v[128:131], v235 offset:19008
    v_mfma_f32_16x16x32_bf16 v[16:19], v[192:195], v[112:115], 0
    s_waitcnt lgkmcnt(10)
    ds_read_b128 v[132:135], v235 offset:19136
    v_mfma_f32_16x16x32_bf16 v[20:23], v[192:195], v[116:119], 0
    s_waitcnt lgkmcnt(10)
    ds_read_b128 v[136:139], v235 offset:19264
    v_mfma_f32_16x16x32_bf16 v[24:27], v[192:195], v[120:123], 0
    s_waitcnt lgkmcnt(9)
    ds_read_b128 v[140:143], v235 offset:19392
    v_mfma_f32_16x16x32_bf16 v[28:31], v[192:195], v[124:127], 0
    s_waitcnt lgkmcnt(8)
    ds_read_b128 v[144:147], v235 offset:19520
    v_mfma_f32_16x16x32_bf16 v[0:3], v[200:203], v[100:103], v[0:3]
    s_waitcnt lgkmcnt(8)
    v_lshlrev_b32 v218, 16, v192
    v_mfma_f32_16x16x32_bf16 v[4:7], v[200:203], v[104:107], v[4:7]
    v_lshlrev_b32 v222, 16, v193
    v_lshlrev_b32 v226, 16, v194
    v_mfma_f32_16x16x32_bf16 v[8:11], v[200:203], v[108:111], v[8:11]
    v_lshlrev_b32 v230, 16, v195
    v_and_b32 v219, s55, v192
    v_mfma_f32_16x16x32_bf16 v[12:15], v[200:203], v[112:115], v[12:15]
    v_and_b32 v223, s55, v193
    v_and_b32 v227, s55, v194
    v_mfma_f32_16x16x32_bf16 v[16:19], v[200:203], v[116:119], v[16:19]
    v_and_b32 v231, s55, v195
    v_lshlrev_b32 v216, 16, v196
    v_mfma_f32_16x16x32_bf16 v[20:23], v[200:203], v[120:123], v[20:23]
    ds_read_b128 v[148:151], v235 offset:19648
    v_mfma_f32_16x16x32_bf16 v[24:27], v[200:203], v[124:127], v[24:27]
    s_waitcnt lgkmcnt(4)
    v_lshlrev_b32 v220, 16, v197
    v_mfma_f32_16x16x32_bf16 v[28:31], v[200:203], v[96:99], v[28:31]
    ds_read_b128 v[152:155], v235 offset:19776
    v_lshlrev_b32 v224, 16, v198
    v_lshlrev_b32 v228, 16, v199
    v_mfma_f32_16x16x32_bf16 v[32:35], v[196:199], v[128:131], 0
    ds_read_b128 v[156:159], v235 offset:19904
    v_and_b32 v217, s55, v196
    v_and_b32 v221, s55, v197
    v_mfma_f32_16x16x32_bf16 v[36:39], v[196:199], v[132:135], 0
    s_waitcnt lgkmcnt(3)
    v_and_b32 v225, s55, v198
    v_and_b32 v229, s55, v199
    v_mfma_f32_16x16x32_bf16 v[40:43], v[196:199], v[136:139], 0
    v_add_f32 v216, v216, v218
    v_add_f32 v220, v220, v222
    v_mfma_f32_16x16x32_bf16 v[44:47], v[196:199], v[140:143], 0
    v_add_f32 v224, v224, v226
    v_add_f32 v228, v228, v230
    v_mfma_f32_16x16x32_bf16 v[48:51], v[196:199], v[144:147], 0
    s_waitcnt lgkmcnt(2)
    v_add_f32 v217, v217, v219
    v_add_f32 v221, v221, v223
    v_mfma_f32_16x16x32_bf16 v[52:55], v[196:199], v[148:151], 0
    s_waitcnt lgkmcnt(1)
    v_add_f32 v225, v225, v227
    v_add_f32 v229, v229, v231
    v_mfma_f32_16x16x32_bf16 v[56:59], v[196:199], v[152:155], 0
    s_waitcnt lgkmcnt(0)
    v_cvt_pk_bf16_f32 v208, v216, v217
    v_cvt_pk_bf16_f32 v209, v220, v221
    v_mfma_f32_16x16x32_bf16 v[60:63], v[196:199], v[156:159], 0
    v_cvt_pk_bf16_f32 v210, v224, v225
    v_cvt_pk_bf16_f32 v211, v228, v229
    v_mfma_f32_16x16x32_bf16 v[32:35], v[204:207], v[132:135], v[32:35]
    v_lshlrev_b32 v218, 16, v200
    v_lshlrev_b32 v222, 16, v201
    ds_read_b128 v[128:131], v235 offset:20064
    v_mfma_f32_16x16x32_bf16 v[36:39], v[204:207], v[136:139], v[36:39]
    v_lshlrev_b32 v226, 16, v202
    v_lshlrev_b32 v230, 16, v203
    ds_read_b128 v[160:163], v235 offset:38016
    v_mfma_f32_16x16x32_bf16 v[40:43], v[204:207], v[140:143], v[40:43]
    v_and_b32 v219, s55, v200
    v_and_b32 v223, s55, v201
    ds_read_b128 v[164:167], v235 offset:38144
    v_mfma_f32_16x16x32_bf16 v[44:47], v[204:207], v[144:147], v[44:47]
    v_and_b32 v227, s55, v202
    v_and_b32 v231, s55, v203
    s_barrier
    ds_read_b128 v[168:171], v235 offset:38272
    v_mfma_f32_16x16x32_bf16 v[48:51], v[204:207], v[148:151], v[48:51]
    v_lshlrev_b32 v216, 16, v204
    v_lshlrev_b32 v220, 16, v205
    ds_read_b128 v[172:175], v235 offset:38400
    v_mfma_f32_16x16x32_bf16 v[52:55], v[204:207], v[152:155], v[52:55]
    v_lshlrev_b32 v224, 16, v206
    v_lshlrev_b32 v228, 16, v207
    ds_read_b128 v[176:179], v235 offset:38528
    v_mfma_f32_16x16x32_bf16 v[56:59], v[204:207], v[156:159], v[56:59]
    s_waitcnt lgkmcnt(5)
    v_and_b32 v217, s55, v204
    v_and_b32 v221, s55, v205
    ds_read_b128 v[180:183], v235 offset:38656
    v_mfma_f32_16x16x32_bf16 v[60:63], v[204:207], v[128:131], v[60:63]
    s_waitcnt lgkmcnt(5)
    v_and_b32 v225, s55, v206
    v_and_b32 v229, s55, v207
    ds_read_b64_tr_b16 v[192:193], v233 offset:16384
    ds_read_b128 v[184:187], v235 offset:38784
    v_mfma_f32_16x16x32_bf16 v[64:67], v[208:211], v[160:163], 0
    s_waitcnt lgkmcnt(6)
    v_add_f32 v216, v216, v218
    v_add_f32 v220, v220, v222
    ds_read_b64_tr_b16 v[194:195], v233 offset:16896
    ds_read_b128 v[188:191], v235 offset:38912
    v_mfma_f32_16x16x32_bf16 v[68:71], v[208:211], v[164:167], 0
    s_waitcnt lgkmcnt(7)
    v_add_f32 v224, v224, v226
    v_add_f32 v228, v228, v230
    ds_read_b64_tr_b16 v[196:197], v233 offset:20480
    v_mfma_f32_16x16x32_bf16 v[72:75], v[208:211], v[168:171], 0
    s_waitcnt lgkmcnt(7)
    v_add_f32 v217, v217, v219
    v_add_f32 v221, v221, v223
    ds_read_b64_tr_b16 v[198:199], v233 offset:20992
    v_mfma_f32_16x16x32_bf16 v[76:79], v[208:211], v[172:175], 0
    s_waitcnt lgkmcnt(7)
    v_add_f32 v225, v225, v227
    v_add_f32 v229, v229, v231
    v_mfma_f32_16x16x32_bf16 v[80:83], v[208:211], v[176:179], 0
    s_waitcnt lgkmcnt(6)
    v_cvt_pk_bf16_f32 v212, v216, v217
    v_cvt_pk_bf16_f32 v213, v220, v221
    v_mfma_f32_16x16x32_bf16 v[84:87], v[208:211], v[180:183], 0
    s_waitcnt lgkmcnt(4)
    v_cvt_pk_bf16_f32 v214, v224, v225
    v_cvt_pk_bf16_f32 v215, v228, v229
    v_mfma_f32_16x16x32_bf16 v[88:91], v[208:211], v[184:187], 0
    s_waitcnt lgkmcnt(2)
    ds_read_b128 v[160:163], v235 offset:39072
    v_mfma_f32_16x16x32_bf16 v[92:95], v[208:211], v[188:191], 0
    ds_read_b128 v[100:103], v235 offset:1184
    v_mfma_f32_16x16x32_bf16 v[64:67], v[212:215], v[164:167], v[64:67]
    ds_read_b128 v[132:135], v235 offset:20192
    v_mfma_f32_16x16x32_bf16 v[68:71], v[212:215], v[168:171], v[68:71]
    ds_read_b128 v[164:167], v235 offset:39200
    v_mfma_f32_16x16x32_bf16 v[72:75], v[212:215], v[172:175], v[72:75]
    s_waitcnt lgkmcnt(4)
    v_lshlrev_b32 v218, 16, v192
    v_mfma_f32_16x16x32_bf16 v[76:79], v[212:215], v[176:179], v[76:79]
    v_lshlrev_b32 v222, 16, v193
    v_lshlrev_b32 v226, 16, v194
    v_mfma_f32_16x16x32_bf16 v[80:83], v[212:215], v[180:183], v[80:83]
    v_lshlrev_b32 v230, 16, v195
    v_and_b32 v219, s55, v192
    v_mfma_f32_16x16x32_bf16 v[84:87], v[212:215], v[184:187], v[84:87]
    v_and_b32 v223, s55, v193
    v_and_b32 v227, s55, v194
    v_mfma_f32_16x16x32_bf16 v[88:91], v[212:215], v[188:191], v[88:91]
    s_waitcnt lgkmcnt(3)
    v_and_b32 v231, s55, v195
    v_mfma_f32_16x16x32_bf16 v[92:95], v[212:215], v[160:163], v[92:95]
    v_lshlrev_b32 v216, 16, v196
    v_lshlrev_b32 v220, 16, v197
    v_mfma_f32_16x16x32_bf16 v[0:3], v[192:195], v[104:107], v[0:3]
    v_lshlrev_b32 v224, 16, v198
    v_lshlrev_b32 v228, 16, v199
    v_mfma_f32_16x16x32_bf16 v[4:7], v[192:195], v[108:111], v[4:7]
    s_barrier
    v_mfma_f32_16x16x32_bf16 v[8:11], v[192:195], v[112:115], v[8:11]
    v_and_b32 v217, s55, v196
    v_and_b32 v221, s55, v197
    v_mfma_f32_16x16x32_bf16 v[12:15], v[192:195], v[116:119], v[12:15]
    v_and_b32 v225, s55, v198
    v_and_b32 v229, s55, v199
    v_mfma_f32_16x16x32_bf16 v[16:19], v[192:195], v[120:123], v[16:19]
    ds_read_b64_tr_b16 v[200:201], v233 offset:24576
    v_mfma_f32_16x16x32_bf16 v[20:23], v[192:195], v[124:127], v[20:23]
    v_add_f32 v216, v216, v218
    v_add_f32 v220, v220, v222
    v_mfma_f32_16x16x32_bf16 v[24:27], v[192:195], v[96:99], v[24:27]
    s_waitcnt lgkmcnt(1)
    ds_read_b64_tr_b16 v[202:203], v233 offset:25088
    v_mfma_f32_16x16x32_bf16 v[28:31], v[192:195], v[100:103], v[28:31]
    v_add_f32 v224, v224, v226
    v_add_f32 v228, v228, v230
    v_mfma_f32_16x16x32_bf16 v[32:35], v[196:199], v[136:139], v[32:35]
    ds_read_b64_tr_b16 v[204:205], v233 offset:28672
    v_mfma_f32_16x16x32_bf16 v[36:39], v[196:199], v[140:143], v[36:39]
    v_add_f32 v217, v217, v219
    v_add_f32 v221, v221, v223
    v_mfma_f32_16x16x32_bf16 v[40:43], v[196:199], v[144:147], v[40:43]
    ds_read_b64_tr_b16 v[206:207], v233 offset:29184
    v_mfma_f32_16x16x32_bf16 v[44:47], v[196:199], v[148:151], v[44:47]
    v_add_f32 v225, v225, v227
    v_add_f32 v229, v229, v231
    v_mfma_f32_16x16x32_bf16 v[48:51], v[196:199], v[152:155], v[48:51]
    v_cvt_pk_bf16_f32 v208, v216, v217
    v_cvt_pk_bf16_f32 v209, v220, v221
    v_mfma_f32_16x16x32_bf16 v[52:55], v[196:199], v[156:159], v[52:55]
    v_cvt_pk_bf16_f32 v210, v224, v225
    v_cvt_pk_bf16_f32 v211, v228, v229
    v_mfma_f32_16x16x32_bf16 v[56:59], v[196:199], v[128:131], v[56:59]
    ds_read_b128 v[104:107], v235 offset:1312
    v_mfma_f32_16x16x32_bf16 v[60:63], v[196:199], v[132:135], v[60:63]
    ds_read_b128 v[136:139], v235 offset:20320
    v_mfma_f32_16x16x32_bf16 v[64:67], v[208:211], v[168:171], v[64:67]
    ds_read_b128 v[168:171], v235 offset:39328
    v_mfma_f32_16x16x32_bf16 v[68:71], v[208:211], v[172:175], v[68:71]
    v_mfma_f32_16x16x32_bf16 v[72:75], v[208:211], v[176:179], v[72:75]
    s_waitcnt lgkmcnt(3)
    v_lshlrev_b32 v218, 16, v200
    v_mfma_f32_16x16x32_bf16 v[76:79], v[208:211], v[180:183], v[76:79]
    v_lshlrev_b32 v222, 16, v201
    v_lshlrev_b32 v226, 16, v202
    v_mfma_f32_16x16x32_bf16 v[80:83], v[208:211], v[184:187], v[80:83]
    v_lshlrev_b32 v230, 16, v203
    v_and_b32 v219, s55, v200
    v_mfma_f32_16x16x32_bf16 v[84:87], v[208:211], v[188:191], v[84:87]
    v_and_b32 v223, s55, v201
    v_and_b32 v227, s55, v202
    v_mfma_f32_16x16x32_bf16 v[88:91], v[208:211], v[160:163], v[88:91]
    v_and_b32 v231, s55, v203
    v_lshlrev_b32 v216, 16, v204
    v_mfma_f32_16x16x32_bf16 v[92:95], v[208:211], v[164:167], v[92:95]
    v_lshlrev_b32 v220, 16, v205
    v_lshlrev_b32 v224, 16, v206
    v_mfma_f32_16x16x32_bf16 v[0:3], v[200:203], v[108:111], v[0:3]
    v_lshlrev_b32 v228, 16, v207
    v_and_b32 v217, s55, v204
    v_mfma_f32_16x16x32_bf16 v[4:7], v[200:203], v[112:115], v[4:7]
    s_barrier
    v_mfma_f32_16x16x32_bf16 v[8:11], v[200:203], v[116:119], v[8:11]
    v_and_b32 v221, s55, v205
    v_and_b32 v225, s55, v206
    v_mfma_f32_16x16x32_bf16 v[12:15], v[200:203], v[120:123], v[12:15]
    v_and_b32 v229, s55, v207
    v_add_f32 v216, v216, v218
    v_mfma_f32_16x16x32_bf16 v[16:19], v[200:203], v[124:127], v[16:19]
    ds_read_b64_tr_b16 v[192:193], v233 offset:32768
    v_mfma_f32_16x16x32_bf16 v[20:23], v[200:203], v[96:99], v[20:23]
    v_add_f32 v220, v220, v222
    v_add_f32 v224, v224, v226
    v_mfma_f32_16x16x32_bf16 v[24:27], v[200:203], v[100:103], v[24:27]
L_pad78:
    s_cbranch_vccnz L_padret78
    s_waitcnt lgkmcnt(1)
    v_mfma_f32_16x16x32_bf16 v[28:31], v[200:203], v[104:107], v[28:31]
    ds_read_b64_tr_b16 v[194:195], v233 offset:33280
    v_mfma_f32_16x16x32_bf16 v[32:35], v[204:207], v[140:143], v[32:35]
    v_add_f32 v228, v228, v230
    v_add_f32 v217, v217, v219
    v_mfma_f32_16x16x32_bf16 v[36:39], v[204:207], v[144:147], v[36:39]
    ds_read_b64_tr_b16 v[196:197], v233 offset:36864
    v_mfma_f32_16x16x32_bf16 v[40:43], v[204:207], v[148:151], v[40:43]
    v_add_f32 v221, v221, v223
    ds_read_b64_tr_b16 v[198:199], v233 offset:37376
    v_mfma_f32_16x16x32_bf16 v[44:47], v[204:207], v[152:155], v[44:47]
    v_add_f32 v225, v225, v227
    v_add_f32 v229, v229, v231
    v_mfma_f32_16x16x32_bf16 v[48:51], v[204:207], v[156:159], v[48:51]
    v_cvt_pk_bf16_f32 v212, v216, v217
    v_cvt_pk_bf16_f32 v213, v220, v221
    v_mfma_f32_16x16x32_bf16 v[52:55], v[204:207], v[128:131], v[52:55]
    v_cvt_pk_bf16_f32 v214, v224, v225
    v_cvt_pk_bf16_f32 v215, v228, v229
    v_mfma_f32_16x16x32_bf16 v[56:59], v[204:207], v[132:135], v[56:59]
    ds_read_b128 v[108:111], v235 offset:1440
    v_mfma_f32_16x16x32_bf16 v[60:63], v[204:207], v[136:139], v[60:63]
    ds_read_b128 v[140:143], v235 offset:20448
    v_mfma_f32_16x16x32_bf16 v[64:67], v[212:215], v[172:175], v[64:67]
    ds_read_b128 v[172:175], v235 offset:39456
    v_mfma_f32_16x16x32_bf16 v[68:71], v[212:215], v[176:179], v[68:71]
    v_mfma_f32_16x16x32_bf16 v[72:75], v[212:215], v[180:183], v[72:75]
    s_waitcnt lgkmcnt(3)
    v_lshlrev_b32 v218, 16, v192
    v_mfma_f32_16x16x32_bf16 v[76:79], v[212:215], v[184:187], v[76:79]
    v_lshlrev_b32 v222, 16, v193
    v_lshlrev_b32 v226, 16, v194
    v_mfma_f32_16x16x32_bf16 v[80:83], v[212:215], v[188:191], v[80:83]
    v_lshlrev_b32 v230, 16, v195
    v_and_b32 v219, s55, v192
    v_mfma_f32_16x16x32_bf16 v[84:87], v[212:215], v[160:163], v[84:87]
    v_and_b32 v223, s55, v193
    v_and_b32 v227, s55, v194
    v_mfma_f32_16x16x32_bf16 v[88:91], v[212:215], v[164:167], v[88:91]
    v_and_b32 v231, s55, v195
    v_lshlrev_b32 v216, 16, v196
    v_mfma_f32_16x16x32_bf16 v[92:95], v[212:215], v[168:171], v[92:95]
    v_lshlrev_b32 v220, 16, v197
    v_lshlrev_b32 v224, 16, v198
    v_mfma_f32_16x16x32_bf16 v[0:3], v[192:195], v[112:115], v[0:3]
    v_lshlrev_b32 v228, 16, v199
    v_and_b32 v217, s55, v196
    v_mfma_f32_16x16x32_bf16 v[4:7], v[192:195], v[116:119], v[4:7]
    s_barrier
    v_mfma_f32_16x16x32_bf16 v[8:11], v[192:195], v[120:123], v[8:11]
    v_and_b32 v221, s55, v197
    v_and_b32 v225, s55, v198
    v_mfma_f32_16x16x32_bf16 v[12:15], v[192:195], v[124:127], v[12:15]
    v_and_b32 v229, s55, v199
    v_add_f32 v216, v216, v218
    v_mfma_f32_16x16x32_bf16 v[16:19], v[192:195], v[96:99], v[16:19]
    ds_read_b64_tr_b16 v[200:201], v233 offset:40960
    v_mfma_f32_16x16x32_bf16 v[20:23], v[192:195], v[100:103], v[20:23]
    v_add_f32 v220, v220, v222
    v_add_f32 v224, v224, v226
    v_mfma_f32_16x16x32_bf16 v[24:27], v[192:195], v[104:107], v[24:27]
    s_waitcnt lgkmcnt(1)
    ds_read_b64_tr_b16 v[202:203], v233 offset:41472
    v_mfma_f32_16x16x32_bf16 v[28:31], v[192:195], v[108:111], v[28:31]
    v_add_f32 v228, v228, v230
    v_add_f32 v217, v217, v219
    v_mfma_f32_16x16x32_bf16 v[32:35], v[196:199], v[144:147], v[32:35]
    ds_read_b64_tr_b16 v[204:205], v233 offset:45056
    v_mfma_f32_16x16x32_bf16 v[36:39], v[196:199], v[148:151], v[36:39]
    v_add_f32 v221, v221, v223
    v_add_f32 v225, v225, v227
    v_mfma_f32_16x16x32_bf16 v[40:43], v[196:199], v[152:155], v[40:43]
    ds_read_b64_tr_b16 v[206:207], v233 offset:45568
    v_mfma_f32_16x16x32_bf16 v[44:47], v[196:199], v[156:159], v[44:47]
    v_add_f32 v229, v229, v231
    v_cvt_pk_bf16_f32 v208, v216, v217
    v_mfma_f32_16x16x32_bf16 v[48:51], v[196:199], v[128:131], v[48:51]
    v_cvt_pk_bf16_f32 v209, v220, v221
    v_cvt_pk_bf16_f32 v210, v224, v225
    v_mfma_f32_16x16x32_bf16 v[52:55], v[196:199], v[132:135], v[52:55]
    v_cvt_pk_bf16_f32 v211, v228, v229
    v_mfma_f32_16x16x32_bf16 v[56:59], v[196:199], v[136:139], v[56:59]
    ds_read_b128 v[112:115], v235 offset:1568
    v_mfma_f32_16x16x32_bf16 v[60:63], v[196:199], v[140:143], v[60:63]
    ds_read_b128 v[144:147], v235 offset:20576
    v_mfma_f32_16x16x32_bf16 v[64:67], v[208:211], v[176:179], v[64:67]
    ds_read_b128 v[176:179], v235 offset:39584
    v_mfma_f32_16x16x32_bf16 v[68:71], v[208:211], v[180:183], v[68:71]
    v_mfma_f32_16x16x32_bf16 v[72:75], v[208:211], v[184:187], v[72:75]
    s_waitcnt lgkmcnt(3)
    v_lshlrev_b32 v218, 16, v200
    v_mfma_f32_16x16x32_bf16 v[76:79], v[208:211], v[188:191], v[76:79]
    v_lshlrev_b32 v222, 16, v201
    v_lshlrev_b32 v226, 16, v202
    v_mfma_f32_16x16x32_bf16 v[80:83], v[208:211], v[160:163], v[80:83]
    v_lshlrev_b32 v230, 16, v203
    v_and_b32 v219, s55, v200
    v_mfma_f32_16x16x32_bf16 v[84:87], v[208:211], v[164:167], v[84:87]
    v_and_b32 v223, s55, v201
    v_and_b32 v227, s55, v202
    v_mfma_f32_16x16x32_bf16 v[88:91], v[208:211], v[168:171], v[88:91]
    v_and_b32 v231, s55, v203
    v_lshlrev_b32 v216, 16, v204
    v_mfma_f32_16x16x32_bf16 v[92:95], v[208:211], v[172:175], v[92:95]
    v_lshlrev_b32 v220, 16, v205
    v_lshlrev_b32 v224, 16, v206
    v_mfma_f32_16x16x32_bf16 v[0:3], v[200:203], v[116:119], v[0:3]
    v_lshlrev_b32 v228, 16, v207
    v_and_b32 v217, s55, v204
    v_mfma_f32_16x16x32_bf16 v[4:7], v[200:203], v[120:123], v[4:7]
    s_barrier
    v_mfma_f32_16x16x32_bf16 v[8:11], v[200:203], v[124:127], v[8:11]
    v_and_b32 v221, s55, v205
    v_and_b32 v225, s55, v206
    v_mfma_f32_16x16x32_bf16 v[12:15], v[200:203], v[96:99], v[12:15]
    v_and_b32 v229, s55, v207
    v_add_f32 v216, v216, v218
    v_mfma_f32_16x16x32_bf16 v[16:19], v[200:203], v[100:103], v[16:19]
    ds_read_b64_tr_b16 v[192:193], v233 offset:49152
    v_mfma_f32_16x16x32_bf16 v[20:23], v[200:203], v[104:107], v[20:23]
    v_add_f32 v220, v220, v222
    v_add_f32 v224, v224, v226
    v_mfma_f32_16x16x32_bf16 v[24:27], v[200:203], v[108:111], v[24:27]
    s_waitcnt lgkmcnt(1)
    ds_read_b64_tr_b16 v[194:195], v233 offset:49664
    v_mfma_f32_16x16x32_bf16 v[28:31], v[200:203], v[112:115], v[28:31]
    v_add_f32 v228, v228, v230
    v_add_f32 v217, v217, v219
    v_mfma_f32_16x16x32_bf16 v[32:35], v[204:207], v[148:151], v[32:35]
    ds_read_b64_tr_b16 v[196:197], v233 offset:53248
    v_mfma_f32_16x16x32_bf16 v[36:39], v[204:207], v[152:155], v[36:39]
    v_add_f32 v221, v221, v223
    v_add_f32 v225, v225, v227
    v_mfma_f32_16x16x32_bf16 v[40:43], v[204:207], v[156:159], v[40:43]
    ds_read_b64_tr_b16 v[198:199], v233 offset:53760
    v_mfma_f32_16x16x32_bf16 v[44:47], v[204:207], v[128:131], v[44:47]
    v_add_f32 v229, v229, v231
    v_cvt_pk_bf16_f32 v212, v216, v217
    v_mfma_f32_16x16x32_bf16 v[48:51], v[204:207], v[132:135], v[48:51]
    v_cvt_pk_bf16_f32 v213, v220, v221
    v_cvt_pk_bf16_f32 v214, v224, v225
    v_mfma_f32_16x16x32_bf16 v[52:55], v[204:207], v[136:139], v[52:55]
    v_cvt_pk_bf16_f32 v215, v228, v229
    v_mfma_f32_16x16x32_bf16 v[56:59], v[204:207], v[140:143], v[56:59]
    ds_read_b128 v[116:119], v235 offset:1696
    v_mfma_f32_16x16x32_bf16 v[60:63], v[204:207], v[144:147], v[60:63]
    ds_read_b128 v[148:151], v235 offset:20704
    v_mfma_f32_16x16x32_bf16 v[64:67], v[212:215], v[180:183], v[64:67]
    ds_read_b128 v[180:183], v235 offset:39712
    v_mfma_f32_16x16x32_bf16 v[68:71], v[212:215], v[184:187], v[68:71]
    v_mfma_f32_16x16x32_bf16 v[72:75], v[212:215], v[188:191], v[72:75]
    s_waitcnt lgkmcnt(3)
    v_lshlrev_b32 v218, 16, v192
    v_mfma_f32_16x16x32_bf16 v[76:79], v[212:215], v[160:163], v[76:79]
    v_lshlrev_b32 v222, 16, v193
    v_lshlrev_b32 v226, 16, v194
    v_mfma_f32_16x16x32_bf16 v[80:83], v[212:215], v[164:167], v[80:83]
    v_lshlrev_b32 v230, 16, v195
    v_and_b32 v219, s55, v192
    v_mfma_f32_16x16x32_bf16 v[84:87], v[212:215], v[168:171], v[84:87]
    v_and_b32 v223, s55, v193
    v_and_b32 v227, s55, v194
    v_mfma_f32_16x16x32_bf16 v[88:91], v[212:215], v[172:175], v[88:91]
    v_and_b32 v231, s55, v195
    v_lshlrev_b32 v216, 16, v196
    v_mfma_f32_16x16x32_bf16 v[92:95], v[212:215], v[176:179], v[92:95]
    v_lshlrev_b32 v220, 16, v197
    v_lshlrev_b32 v224, 16, v198
    v_mfma_f32_16x16x32_bf16 v[0:3], v[192:195], v[120:123], v[0:3]
    v_lshlrev_b32 v228, 16, v199
    v_and_b32 v217, s55, v196
    v_mfma_f32_16x16x32_bf16 v[4:7], v[192:195], v[124:127], v[4:7]
    s_barrier
    v_mfma_f32_16x16x32_bf16 v[8:11], v[192:195], v[96:99], v[8:11]
    v_and_b32 v221, s55, v197
    v_and_b32 v225, s55, v198
    v_mfma_f32_16x16x32_bf16 v[12:15], v[192:195], v[100:103], v[12:15]
    v_and_b32 v229, s55, v199
    v_add_f32 v216, v216, v218
    v_mfma_f32_16x16x32_bf16 v[16:19], v[192:195], v[104:107], v[16:19]
    ds_read_b64_tr_b16 v[200:201], v234 offset:0
    v_mfma_f32_16x16x32_bf16 v[20:23], v[192:195], v[108:111], v[20:23]
    v_add_f32 v220, v220, v222
    v_add_f32 v224, v224, v226
    v_mfma_f32_16x16x32_bf16 v[24:27], v[192:195], v[112:115], v[24:27]
    s_waitcnt lgkmcnt(1)
    ds_read_b64_tr_b16 v[202:203], v234 offset:512
    v_mfma_f32_16x16x32_bf16 v[28:31], v[192:195], v[116:119], v[28:31]
    v_add_f32 v228, v228, v230
    v_add_f32 v217, v217, v219
    v_mfma_f32_16x16x32_bf16 v[32:35], v[196:199], v[152:155], v[32:35]
    ds_read_b64_tr_b16 v[204:205], v234 offset:4096
    v_mfma_f32_16x16x32_bf16 v[36:39], v[196:199], v[156:159], v[36:39]
    v_add_f32 v221, v221, v223
    v_add_f32 v225, v225, v227
    v_mfma_f32_16x16x32_bf16 v[40:43], v[196:199], v[128:131], v[40:43]
    ds_read_b64_tr_b16 v[206:207], v234 offset:4608
    v_mfma_f32_16x16x32_bf16 v[44:47], v[196:199], v[132:135], v[44:47]
    v_add_f32 v229, v229, v231
    v_cvt_pk_bf16_f32 v208, v216, v217
    v_mfma_f32_16x16x32_bf16 v[48:51], v[196:199], v[136:139], v[48:51]
    v_cvt_pk_bf16_f32 v209, v220, v221
    v_cvt_pk_bf16_f32 v210, v224, v225
    v_mfma_f32_16x16x32_bf16 v[52:55], v[196:199], v[140:143], v[52:55]
    v_cvt_pk_bf16_f32 v211, v228, v229
    v_mfma_f32_16x16x32_bf16 v[56:59], v[196:199], v[144:147], v[56:59]
    ds_read_b128 v[120:123], v235 offset:1824
    v_mfma_f32_16x16x32_bf16 v[60:63], v[196:199], v[148:151], v[60:63]
    ds_read_b128 v[152:155], v235 offset:20832
    v_mfma_f32_16x16x32_bf16 v[64:67], v[208:211], v[184:187], v[64:67]
    ds_read_b128 v[184:187], v235 offset:39840
    v_mfma_f32_16x16x32_bf16 v[68:71], v[208:211], v[188:191], v[68:71]
    v_mfma_f32_16x16x32_bf16 v[72:75], v[208:211], v[160:163], v[72:75]
    s_waitcnt lgkmcnt(3)
    v_lshlrev_b32 v218, 16, v200
    v_mfma_f32_16x16x32_bf16 v[76:79], v[208:211], v[164:167], v[76:79]
    v_lshlrev_b32 v222, 16, v201
    v_lshlrev_b32 v226, 16, v202
    v_mfma_f32_16x16x32_bf16 v[80:83], v[208:211], v[168:171], v[80:83]
    v_lshlrev_b32 v230, 16, v203
    v_and_b32 v219, s55, v200
    v_mfma_f32_16x16x32_bf16 v[84:87], v[208:211], v[172:175], v[84:87]
    v_and_b32 v223, s55, v201
    v_and_b32 v227, s55, v202
    v_mfma_f32_16x16x32_bf16 v[88:91], v[208:211], v[176:179], v[88:91]
    v_and_b32 v231, s55, v203
    v_lshlrev_b32 v216, 16, v204
    v_mfma_f32_16x16x32_bf16 v[92:95], v[208:211], v[180:183], v[92:95]
    v_lshlrev_b32 v220, 16, v205
    v_lshlrev_b32 v224, 16, v206
    v_mfma_f32_16x16x32_bf16 v[0:3], v[200:203], v[124:127], v[0:3]
    v_lshlrev_b32 v228, 16, v207
    v_and_b32 v217, s55, v204
    v_mfma_f32_16x16x32_bf16 v[4:7], v[200:203], v[96:99], v[4:7]
    s_barrier
    v_mfma_f32_16x16x32_bf16 v[8:11], v[200:203], v[100:103], v[8:11]
    v_and_b32 v221, s55, v205
    v_and_b32 v225, s55, v206
    v_mfma_f32_16x16x32_bf16 v[12:15], v[200:203], v[104:107], v[12:15]
    v_and_b32 v229, s55, v207
    v_add_f32 v216, v216, v218
    v_mfma_f32_16x16x32_bf16 v[16:19], v[200:203], v[108:111], v[16:19]
    ds_read_b64_tr_b16 v[192:193], v234 offset:8192
    v_mfma_f32_16x16x32_bf16 v[20:23], v[200:203], v[112:115], v[20:23]
    v_add_f32 v220, v220, v222
    v_add_f32 v224, v224, v226
    v_mfma_f32_16x16x32_bf16 v[24:27], v[200:203], v[116:119], v[24:27]
    s_waitcnt lgkmcnt(1)
    ds_read_b64_tr_b16 v[194:195], v234 offset:8704
    v_mfma_f32_16x16x32_bf16 v[28:31], v[200:203], v[120:123], v[28:31]
    v_add_f32 v228, v228, v230
    v_add_f32 v217, v217, v219
    v_mfma_f32_16x16x32_bf16 v[32:35], v[204:207], v[156:159], v[32:35]
    ds_read_b64_tr_b16 v[196:197], v234 offset:12288
    v_mfma_f32_16x16x32_bf16 v[36:39], v[204:207], v[128:131], v[36:39]
    v_add_f32 v221, v221, v223
    v_add_f32 v225, v225, v227
    v_mfma_f32_16x16x32_bf16 v[40:43], v[204:207], v[132:135], v[40:43]
    ds_read_b64_tr_b16 v[198:199], v234 offset:12800
    v_mfma_f32_16x16x32_bf16 v[44:47], v[204:207], v[136:139], v[44:47]
    v_add_f32 v229, v229, v231
    v_cvt_pk_bf16_f32 v212, v216, v217
    v_mfma_f32_16x16x32_bf16 v[48:51], v[204:207], v[140:143], v[48:51]
    v_cvt_pk_bf16_f32 v213, v220, v221
    v_cvt_pk_bf16_f32 v214, v224, v225
    v_mfma_f32_16x16x32_bf16 v[52:55], v[204:207], v[144:147], v[52:55]
    v_cvt_pk_bf16_f32 v215, v228, v229
    v_mfma_f32_16x16x32_bf16 v[56:59], v[204:207], v[148:151], v[56:59]
    ds_read_b128 v[124:127], v235 offset:1952
    v_mfma_f32_16x16x32_bf16 v[60:63], v[204:207], v[152:155], v[60:63]
    ds_read_b128 v[156:159], v235 offset:20960
    v_mfma_f32_16x16x32_bf16 v[64:67], v[212:215], v[188:191], v[64:67]
    ds_read_b128 v[188:191], v235 offset:39968
    v_mfma_f32_16x16x32_bf16 v[68:71], v[212:215], v[160:163], v[68:71]
    v_mfma_f32_16x16x32_bf16 v[72:75], v[212:215], v[164:167], v[72:75]
    s_waitcnt lgkmcnt(3)
    v_lshlrev_b32 v218, 16, v192
    v_mfma_f32_16x16x32_bf16 v[76:79], v[212:215], v[168:171], v[76:79]
    v_lshlrev_b32 v222, 16, v193
    v_lshlrev_b32 v226, 16, v194
    v_mfma_f32_16x16x32_bf16 v[80:83], v[212:215], v[172:175], v[80:83]
    v_lshlrev_b32 v230, 16, v195
    v_and_b32 v219, s55, v192
    v_mfma_f32_16x16x32_bf16 v[84:87], v[212:215], v[176:179], v[84:87]
    v_and_b32 v223, s55, v193
    v_and_b32 v227, s55, v194
    v_mfma_f32_16x16x32_bf16 v[88:91], v[212:215], v[180:183], v[88:91]
    v_and_b32 v231, s55, v195
    v_lshlrev_b32 v216, 16, v196
    v_mfma_f32_16x16x32_bf16 v[92:95], v[212:215], v[184:187], v[92:95]
    v_lshlrev_b32 v220, 16, v197
    v_lshlrev_b32 v224, 16, v198
    v_mfma_f32_16x16x32_bf16 v[0:3], v[192:195], v[96:99], v[0:3]
    v_lshlrev_b32 v228, 16, v199
    v_and_b32 v217, s55, v196
    v_mfma_f32_16x16x32_bf16 v[4:7], v[192:195], v[100:103], v[4:7]
    s_barrier
    v_mfma_f32_16x16x32_bf16 v[8:11], v[192:195], v[104:107], v[8:11]
    v_and_b32 v221, s55, v197
    v_and_b32 v225, s55, v198
    v_mfma_f32_16x16x32_bf16 v[12:15], v[192:195], v[108:111], v[12:15]
    v_and_b32 v229, s55, v199
    v_add_f32 v216, v216, v218
    v_mfma_f32_16x16x32_bf16 v[16:19], v[192:195], v[112:115], v[16:19]
    ds_read_b64_tr_b16 v[200:201], v234 offset:16384
    v_mfma_f32_16x16x32_bf16 v[20:23], v[192:195], v[116:119], v[20:23]
    v_add_f32 v220, v220, v222
    v_add_f32 v224, v224, v226
    v_mfma_f32_16x16x32_bf16 v[24:27], v[192:195], v[120:123], v[24:27]
    s_waitcnt lgkmcnt(1)
    ds_read_b64_tr_b16 v[202:203], v234 offset:16896
    v_mfma_f32_16x16x32_bf16 v[28:31], v[192:195], v[124:127], v[28:31]
    v_add_f32 v228, v228, v230
    v_add_f32 v217, v217, v219
    v_mfma_f32_16x16x32_bf16 v[32:35], v[196:199], v[128:131], v[32:35]
    ds_read_b64_tr_b16 v[204:205], v234 offset:20480
    v_mfma_f32_16x16x32_bf16 v[36:39], v[196:199], v[132:135], v[36:39]
    v_add_f32 v221, v221, v223
    v_add_f32 v225, v225, v227
    v_mfma_f32_16x16x32_bf16 v[40:43], v[196:199], v[136:139], v[40:43]
    ds_read_b64_tr_b16 v[206:207], v234 offset:20992
    v_mfma_f32_16x16x32_bf16 v[44:47], v[196:199], v[140:143], v[44:47]
    v_add_f32 v229, v229, v231
    v_cvt_pk_bf16_f32 v208, v216, v217
    v_mfma_f32_16x16x32_bf16 v[48:51], v[196:199], v[144:147], v[48:51]
    v_cvt_pk_bf16_f32 v209, v220, v221
    v_cvt_pk_bf16_f32 v210, v224, v225
    v_mfma_f32_16x16x32_bf16 v[52:55], v[196:199], v[148:151], v[52:55]
    v_cvt_pk_bf16_f32 v211, v228, v229
    v_mfma_f32_16x16x32_bf16 v[56:59], v[196:199], v[152:155], v[56:59]
    ds_read_b128 v[96:99], v235 offset:2112
    v_mfma_f32_16x16x32_bf16 v[60:63], v[196:199], v[156:159], v[60:63]
    ds_read_b128 v[128:131], v235 offset:21120
    v_mfma_f32_16x16x32_bf16 v[64:67], v[208:211], v[160:163], v[64:67]
    ds_read_b128 v[160:163], v235 offset:40128
    v_mfma_f32_16x16x32_bf16 v[68:71], v[208:211], v[164:167], v[68:71]
    v_mfma_f32_16x16x32_bf16 v[72:75], v[208:211], v[168:171], v[72:75]
    s_waitcnt lgkmcnt(3)
    v_lshlrev_b32 v218, 16, v200
    v_mfma_f32_16x16x32_bf16 v[76:79], v[208:211], v[172:175], v[76:79]
    v_lshlrev_b32 v222, 16, v201
    v_lshlrev_b32 v226, 16, v202
    v_mfma_f32_16x16x32_bf16 v[80:83], v[208:211], v[176:179], v[80:83]
    v_lshlrev_b32 v230, 16, v203
    v_and_b32 v219, s55, v200
    v_mfma_f32_16x16x32_bf16 v[84:87], v[208:211], v[180:183], v[84:87]
    v_and_b32 v223, s55, v201
    v_and_b32 v227, s55, v202
    v_mfma_f32_16x16x32_bf16 v[88:91], v[208:211], v[184:187], v[88:91]
    v_and_b32 v231, s55, v203
    v_lshlrev_b32 v216, 16, v204
    v_mfma_f32_16x16x32_bf16 v[92:95], v[208:211], v[188:191], v[92:95]
    v_lshlrev_b32 v220, 16, v205
    v_lshlrev_b32 v224, 16, v206
    v_mfma_f32_16x16x32_bf16 v[0:3], v[200:203], v[100:103], v[0:3]
    v_lshlrev_b32 v228, 16, v207
    v_and_b32 v217, s55, v204
    v_mfma_f32_16x16x32_bf16 v[4:7], v[200:203], v[104:107], v[4:7]
    s_barrier
    v_mfma_f32_16x16x32_bf16 v[8:11], v[200:203], v[108:111], v[8:11]
    v_and_b32 v221, s55, v205
    v_and_b32 v225, s55, v206
    v_mfma_f32_16x16x32_bf16 v[12:15], v[200:203], v[112:115], v[12:15]
    v_and_b32 v229, s55, v207
    v_add_f32 v216, v216, v218
    v_mfma_f32_16x16x32_bf16 v[16:19], v[200:203], v[116:119], v[16:19]
    ds_read_b64_tr_b16 v[192:193], v234 offset:24576
    v_mfma_f32_16x16x32_bf16 v[20:23], v[200:203], v[120:123], v[20:23]
    v_add_f32 v220, v220, v222
    v_add_f32 v224, v224, v226
    v_mfma_f32_16x16x32_bf16 v[24:27], v[200:203], v[124:127], v[24:27]
    s_waitcnt lgkmcnt(1)
    ds_read_b64_tr_b16 v[194:195], v234 offset:25088
    v_mfma_f32_16x16x32_bf16 v[28:31], v[200:203], v[96:99], v[28:31]
    v_add_f32 v228, v228, v230
    v_add_f32 v217, v217, v219
    v_mfma_f32_16x16x32_bf16 v[32:35], v[204:207], v[132:135], v[32:35]
    ds_read_b64_tr_b16 v[196:197], v234 offset:28672
    v_mfma_f32_16x16x32_bf16 v[36:39], v[204:207], v[136:139], v[36:39]
    v_add_f32 v221, v221, v223
    v_add_f32 v225, v225, v227
    v_mfma_f32_16x16x32_bf16 v[40:43], v[204:207], v[140:143], v[40:43]
    ds_read_b64_tr_b16 v[198:199], v234 offset:29184
    v_mfma_f32_16x16x32_bf16 v[44:47], v[204:207], v[144:147], v[44:47]
    v_add_f32 v229, v229, v231
    v_cvt_pk_bf16_f32 v212, v216, v217
    v_mfma_f32_16x16x32_bf16 v[48:51], v[204:207], v[148:151], v[48:51]
    v_cvt_pk_bf16_f32 v213, v220, v221
    v_cvt_pk_bf16_f32 v214, v224, v225
    v_mfma_f32_16x16x32_bf16 v[52:55], v[204:207], v[152:155], v[52:55]
    v_cvt_pk_bf16_f32 v215, v228, v229
    v_mfma_f32_16x16x32_bf16 v[56:59], v[204:207], v[156:159], v[56:59]
    ds_read_b128 v[100:103], v235 offset:2240
    v_mfma_f32_16x16x32_bf16 v[60:63], v[204:207], v[128:131], v[60:63]
    ds_read_b128 v[132:135], v235 offset:21248
    v_mfma_f32_16x16x32_bf16 v[64:67], v[212:215], v[164:167], v[64:67]
    ds_read_b128 v[164:167], v235 offset:40256
    v_mfma_f32_16x16x32_bf16 v[68:71], v[212:215], v[168:171], v[68:71]
    v_mfma_f32_16x16x32_bf16 v[72:75], v[212:215], v[172:175], v[72:75]
    s_waitcnt lgkmcnt(3)
    v_lshlrev_b32 v218, 16, v192
    v_mfma_f32_16x16x32_bf16 v[76:79], v[212:215], v[176:179], v[76:79]
    v_lshlrev_b32 v222, 16, v193
    v_lshlrev_b32 v226, 16, v194
    v_mfma_f32_16x16x32_bf16 v[80:83], v[212:215], v[180:183], v[80:83]
    v_lshlrev_b32 v230, 16, v195
    v_and_b32 v219, s55, v192
    v_mfma_f32_16x16x32_bf16 v[84:87], v[212:215], v[184:187], v[84:87]
    v_and_b32 v223, s55, v193
    v_and_b32 v227, s55, v194
    v_mfma_f32_16x16x32_bf16 v[88:91], v[212:215], v[188:191], v[88:91]
    v_and_b32 v231, s55, v195
    v_lshlrev_b32 v216, 16, v196
    v_mfma_f32_16x16x32_bf16 v[92:95], v[212:215], v[160:163], v[92:95]
    v_lshlrev_b32 v220, 16, v197
    v_lshlrev_b32 v224, 16, v198
    v_mfma_f32_16x16x32_bf16 v[0:3], v[192:195], v[104:107], v[0:3]
    v_lshlrev_b32 v228, 16, v199
    v_and_b32 v217, s55, v196
    v_mfma_f32_16x16x32_bf16 v[4:7], v[192:195], v[108:111], v[4:7]
    s_barrier
    v_mfma_f32_16x16x32_bf16 v[8:11], v[192:195], v[112:115], v[8:11]
    v_and_b32 v221, s55, v197
    v_and_b32 v225, s55, v198
    v_mfma_f32_16x16x32_bf16 v[12:15], v[192:195], v[116:119], v[12:15]
    v_and_b32 v229, s55, v199
    v_add_f32 v216, v216, v218
    v_mfma_f32_16x16x32_bf16 v[16:19], v[192:195], v[120:123], v[16:19]
    ds_read_b64_tr_b16 v[200:201], v234 offset:32768
    v_mfma_f32_16x16x32_bf16 v[20:23], v[192:195], v[124:127], v[20:23]
    v_add_f32 v220, v220, v222
    v_add_f32 v224, v224, v226
    v_mfma_f32_16x16x32_bf16 v[24:27], v[192:195], v[96:99], v[24:27]
    s_waitcnt lgkmcnt(1)
    ds_read_b64_tr_b16 v[202:203], v234 offset:33280
    v_mfma_f32_16x16x32_bf16 v[28:31], v[192:195], v[100:103], v[28:31]
    v_add_f32 v228, v228, v230
    v_add_f32 v217, v217, v219
    v_mfma_f32_16x16x32_bf16 v[32:35], v[196:199], v[136:139], v[32:35]
    ds_read_b64_tr_b16 v[204:205], v234 offset:36864
    v_mfma_f32_16x16x32_bf16 v[36:39], v[196:199], v[140:143], v[36:39]
    v_add_f32 v221, v221, v223
    v_add_f32 v225, v225, v227
    v_mfma_f32_16x16x32_bf16 v[40:43], v[196:199], v[144:147], v[40:43]
    ds_read_b64_tr_b16 v[206:207], v234 offset:37376
    v_mfma_f32_16x16x32_bf16 v[44:47], v[196:199], v[148:151], v[44:47]
    v_add_f32 v229, v229, v231
    v_cvt_pk_bf16_f32 v208, v216, v217
    v_mfma_f32_16x16x32_bf16 v[48:51], v[196:199], v[152:155], v[48:51]
    v_cvt_pk_bf16_f32 v209, v220, v221
    v_cvt_pk_bf16_f32 v210, v224, v225
    v_mfma_f32_16x16x32_bf16 v[52:55], v[196:199], v[156:159], v[52:55]
    v_cvt_pk_bf16_f32 v211, v228, v229
    v_mfma_f32_16x16x32_bf16 v[56:59], v[196:199], v[128:131], v[56:59]
    ds_read_b128 v[104:107], v235 offset:2368
    v_mfma_f32_16x16x32_bf16 v[60:63], v[196:199], v[132:135], v[60:63]
    ds_read_b128 v[136:139], v235 offset:21376
    v_mfma_f32_16x16x32_bf16 v[64:67], v[208:211], v[168:171], v[64:67]
    ds_read_b128 v[168:171], v235 offset:40384
    v_mfma_f32_16x16x32_bf16 v[68:71], v[208:211], v[172:175], v[68:71]
    v_mfma_f32_16x16x32_bf16 v[72:75], v[208:211], v[176:179], v[72:75]
    s_waitcnt lgkmcnt(3)
    v_lshlrev_b32 v218, 16, v200
    v_mfma_f32_16x16x32_bf16 v[76:79], v[208:211], v[180:183], v[76:79]
    v_lshlrev_b32 v222, 16, v201
    v_lshlrev_b32 v226, 16, v202
    v_mfma_f32_16x16x32_bf16 v[80:83], v[208:211], v[184:187], v[80:83]
    v_lshlrev_b32 v230, 16, v203
    v_and_b32 v219, s55, v200
    v_mfma_f32_16x16x32_bf16 v[84:87], v[208:211], v[188:191], v[84:87]
    v_and_b32 v223, s55, v201
    v_and_b32 v227, s55, v202
    v_mfma_f32_16x16x32_bf16 v[88:91], v[208:211], v[160:163], v[88:91]
    v_and_b32 v231, s55, v203
    v_lshlrev_b32 v216, 16, v204
    v_mfma_f32_16x16x32_bf16 v[92:95], v[208:211], v[164:167], v[92:95]
    v_lshlrev_b32 v220, 16, v205
    v_lshlrev_b32 v224, 16, v206
    v_mfma_f32_16x16x32_bf16 v[0:3], v[200:203], v[108:111], v[0:3]
    v_lshlrev_b32 v228, 16, v207
    v_and_b32 v217, s55, v204
    v_mfma_f32_16x16x32_bf16 v[4:7], v[200:203], v[112:115], v[4:7]
    s_barrier
    v_mfma_f32_16x16x32_bf16 v[8:11], v[200:203], v[116:119], v[8:11]
    v_and_b32 v221, s55, v205
    v_and_b32 v225, s55, v206
    v_mfma_f32_16x16x32_bf16 v[12:15], v[200:203], v[120:123], v[12:15]
    v_and_b32 v229, s55, v207
    v_add_f32 v216, v216, v218
    v_mfma_f32_16x16x32_bf16 v[16:19], v[200:203], v[124:127], v[16:19]
    ds_read_b64_tr_b16 v[192:193], v234 offset:40960
    v_mfma_f32_16x16x32_bf16 v[20:23], v[200:203], v[96:99], v[20:23]
    v_add_f32 v220, v220, v222
    v_add_f32 v224, v224, v226
    v_mfma_f32_16x16x32_bf16 v[24:27], v[200:203], v[100:103], v[24:27]
    s_waitcnt lgkmcnt(1)
    ds_read_b64_tr_b16 v[194:195], v234 offset:41472
    v_mfma_f32_16x16x32_bf16 v[28:31], v[200:203], v[104:107], v[28:31]
    v_add_f32 v228, v228, v230
    v_add_f32 v217, v217, v219
    v_mfma_f32_16x16x32_bf16 v[32:35], v[204:207], v[140:143], v[32:35]
    ds_read_b64_tr_b16 v[196:197], v234 offset:45056
    v_mfma_f32_16x16x32_bf16 v[36:39], v[204:207], v[144:147], v[36:39]
    v_add_f32 v221, v221, v223
    v_add_f32 v225, v225, v227
    v_mfma_f32_16x16x32_bf16 v[40:43], v[204:207], v[148:151], v[40:43]
    ds_read_b64_tr_b16 v[198:199], v234 offset:45568
    v_mfma_f32_16x16x32_bf16 v[44:47], v[204:207], v[152:155], v[44:47]
    v_add_f32 v229, v229, v231
    v_cvt_pk_bf16_f32 v212, v216, v217
    v_mfma_f32_16x16x32_bf16 v[48:51], v[204:207], v[156:159], v[48:51]
    v_cvt_pk_bf16_f32 v213, v220, v221
    v_cvt_pk_bf16_f32 v214, v224, v225
    v_mfma_f32_16x16x32_bf16 v[52:55], v[204:207], v[128:131], v[52:55]
    v_cvt_pk_bf16_f32 v215, v228, v229
    v_mfma_f32_16x16x32_bf16 v[56:59], v[204:207], v[132:135], v[56:59]
    ds_read_b128 v[108:111], v235 offset:2496
    v_mfma_f32_16x16x32_bf16 v[60:63], v[204:207], v[136:139], v[60:63]
    ds_read_b128 v[140:143], v235 offset:21504
    v_mfma_f32_16x16x32_bf16 v[64:67], v[212:215], v[172:175], v[64:67]
    ds_read_b128 v[172:175], v235 offset:40512
    v_mfma_f32_16x16x32_bf16 v[68:71], v[212:215], v[176:179], v[68:71]
    v_mfma_f32_16x16x32_bf16 v[72:75], v[212:215], v[180:183], v[72:75]
    s_waitcnt lgkmcnt(3)
    v_lshlrev_b32 v218, 16, v192
    v_mfma_f32_16x16x32_bf16 v[76:79], v[212:215], v[184:187], v[76:79]
    v_lshlrev_b32 v222, 16, v193
    v_lshlrev_b32 v226, 16, v194
    v_mfma_f32_16x16x32_bf16 v[80:83], v[212:215], v[188:191], v[80:83]
    v_lshlrev_b32 v230, 16, v195
    v_and_b32 v219, s55, v192
    v_mfma_f32_16x16x32_bf16 v[84:87], v[212:215], v[160:163], v[84:87]
    v_and_b32 v223, s55, v193
    v_and_b32 v227, s55, v194
    v_mfma_f32_16x16x32_bf16 v[88:91], v[212:215], v[164:167], v[88:91]
    v_and_b32 v231, s55, v195
    v_lshlrev_b32 v216, 16, v196
    v_mfma_f32_16x16x32_bf16 v[92:95], v[212:215], v[168:171], v[92:95]
    v_lshlrev_b32 v220, 16, v197
    v_lshlrev_b32 v224, 16, v198
    v_mfma_f32_16x16x32_bf16 v[0:3], v[192:195], v[112:115], v[0:3]
    v_lshlrev_b32 v228, 16, v199
    v_and_b32 v217, s55, v196
    v_mfma_f32_16x16x32_bf16 v[4:7], v[192:195], v[116:119], v[4:7]
    s_barrier
    v_mfma_f32_16x16x32_bf16 v[8:11], v[192:195], v[120:123], v[8:11]
    v_and_b32 v221, s55, v197
    v_and_b32 v225, s55, v198
    v_mfma_f32_16x16x32_bf16 v[12:15], v[192:195], v[124:127], v[12:15]
    v_and_b32 v229, s55, v199
    v_add_f32 v216, v216, v218
    v_mfma_f32_16x16x32_bf16 v[16:19], v[192:195], v[96:99], v[16:19]
    ds_read_b64_tr_b16 v[200:201], v233 offset:0
    v_mfma_f32_16x16x32_bf16 v[20:23], v[192:195], v[100:103], v[20:23]
    v_add_f32 v220, v220, v222
    v_add_f32 v224, v224, v226
    v_mfma_f32_16x16x32_bf16 v[24:27], v[192:195], v[104:107], v[24:27]
    s_waitcnt lgkmcnt(1)
    ds_read_b64_tr_b16 v[202:203], v233 offset:512
    v_mfma_f32_16x16x32_bf16 v[28:31], v[192:195], v[108:111], v[28:31]
    v_add_f32 v228, v228, v230
    v_add_f32 v217, v217, v219
    v_mfma_f32_16x16x32_bf16 v[32:35], v[196:199], v[144:147], v[32:35]
    ds_read_b64_tr_b16 v[204:205], v233 offset:4096
    v_mfma_f32_16x16x32_bf16 v[36:39], v[196:199], v[148:151], v[36:39]
    v_add_f32 v221, v221, v223
    v_add_f32 v225, v225, v227
    v_mfma_f32_16x16x32_bf16 v[40:43], v[196:199], v[152:155], v[40:43]
    ds_read_b64_tr_b16 v[206:207], v233 offset:4608
    v_mfma_f32_16x16x32_bf16 v[44:47], v[196:199], v[156:159], v[44:47]
    v_add_f32 v229, v229, v231
    v_cvt_pk_bf16_f32 v208, v216, v217
    v_mfma_f32_16x16x32_bf16 v[48:51], v[196:199], v[128:131], v[48:51]
    v_cvt_pk_bf16_f32 v209, v220, v221
    v_cvt_pk_bf16_f32 v210, v224, v225
    v_mfma_f32_16x16x32_bf16 v[52:55], v[196:199], v[132:135], v[52:55]
    v_cvt_pk_bf16_f32 v211, v228, v229
    v_mfma_f32_16x16x32_bf16 v[56:59], v[196:199], v[136:139], v[56:59]
    ds_read_b128 v[112:115], v235 offset:2624
    v_mfma_f32_16x16x32_bf16 v[60:63], v[196:199], v[140:143], v[60:63]
    ds_read_b128 v[144:147], v235 offset:21632
    v_mfma_f32_16x16x32_bf16 v[64:67], v[208:211], v[176:179], v[64:67]
    ds_read_b128 v[176:179], v235 offset:40640
    v_mfma_f32_16x16x32_bf16 v[68:71], v[208:211], v[180:183], v[68:71]
    v_mfma_f32_16x16x32_bf16 v[72:75], v[208:211], v[184:187], v[72:75]
    s_waitcnt lgkmcnt(3)
    v_lshlrev_b32 v218, 16, v200
    v_mfma_f32_16x16x32_bf16 v[76:79], v[208:211], v[188:191], v[76:79]
    v_lshlrev_b32 v222, 16, v201
    v_lshlrev_b32 v226, 16, v202
    v_mfma_f32_16x16x32_bf16 v[80:83], v[208:211], v[160:163], v[80:83]
    v_lshlrev_b32 v230, 16, v203
    v_and_b32 v219, s55, v200
    v_mfma_f32_16x16x32_bf16 v[84:87], v[208:211], v[164:167], v[84:87]
    v_and_b32 v223, s55, v201
    v_and_b32 v227, s55, v202
    v_mfma_f32_16x16x32_bf16 v[88:91], v[208:211], v[168:171], v[88:91]
    v_and_b32 v231, s55, v203
    v_lshlrev_b32 v216, 16, v204
    v_mfma_f32_16x16x32_bf16 v[92:95], v[208:211], v[172:175], v[92:95]
    v_lshlrev_b32 v220, 16, v205
    v_lshlrev_b32 v224, 16, v206
    v_mfma_f32_16x16x32_bf16 v[0:3], v[200:203], v[116:119], v[0:3]
    v_lshlrev_b32 v228, 16, v207
    v_and_b32 v217, s55, v204
    v_mfma_f32_16x16x32_bf16 v[4:7], v[200:203], v[120:123], v[4:7]
    s_barrier
    v_mfma_f32_16x16x32_bf16 v[8:11], v[200:203], v[124:127], v[8:11]
    v_and_b32 v221, s55, v205
    v_and_b32 v225, s55, v206
    v_mfma_f32_16x16x32_bf16 v[12:15], v[200:203], v[96:99], v[12:15]
    v_and_b32 v229, s55, v207
    v_add_f32 v216, v216, v218
    v_mfma_f32_16x16x32_bf16 v[16:19], v[200:203], v[100:103], v[16:19]
    ds_read_b64_tr_b16 v[192:193], v233 offset:8192
    v_mfma_f32_16x16x32_bf16 v[20:23], v[200:203], v[104:107], v[20:23]
    v_add_f32 v220, v220, v222
    v_add_f32 v224, v224, v226
    v_mfma_f32_16x16x32_bf16 v[24:27], v[200:203], v[108:111], v[24:27]
    s_waitcnt lgkmcnt(1)
    ds_read_b64_tr_b16 v[194:195], v233 offset:8704
    v_mfma_f32_16x16x32_bf16 v[28:31], v[200:203], v[112:115], v[28:31]
    v_add_f32 v228, v228, v230
    v_add_f32 v217, v217, v219
    v_mfma_f32_16x16x32_bf16 v[32:35], v[204:207], v[148:151], v[32:35]
    ds_read_b64_tr_b16 v[196:197], v233 offset:12288
    v_mfma_f32_16x16x32_bf16 v[36:39], v[204:207], v[152:155], v[36:39]
    v_add_f32 v221, v221, v223
    v_add_f32 v225, v225, v227
    v_mfma_f32_16x16x32_bf16 v[40:43], v[204:207], v[156:159], v[40:43]
    ds_read_b64_tr_b16 v[198:199], v233 offset:12800
    v_mfma_f32_16x16x32_bf16 v[44:47], v[204:207], v[128:131], v[44:47]
    v_add_f32 v229, v229, v231
    v_cvt_pk_bf16_f32 v212, v216, v217
    v_mfma_f32_16x16x32_bf16 v[48:51], v[204:207], v[132:135], v[48:51]
    v_cvt_pk_bf16_f32 v213, v220, v221
    v_cvt_pk_bf16_f32 v214, v224, v225
    v_mfma_f32_16x16x32_bf16 v[52:55], v[204:207], v[136:139], v[52:55]
    v_cvt_pk_bf16_f32 v215, v228, v229
    v_mfma_f32_16x16x32_bf16 v[56:59], v[204:207], v[140:143], v[56:59]
    ds_read_b128 v[116:119], v235 offset:2752
    v_mfma_f32_16x16x32_bf16 v[60:63], v[204:207], v[144:147], v[60:63]
    ds_read_b128 v[148:151], v235 offset:21760
    v_mfma_f32_16x16x32_bf16 v[64:67], v[212:215], v[180:183], v[64:67]
    ds_read_b128 v[180:183], v235 offset:40768
    v_mfma_f32_16x16x32_bf16 v[68:71], v[212:215], v[184:187], v[68:71]
    v_mfma_f32_16x16x32_bf16 v[72:75], v[212:215], v[188:191], v[72:75]
    s_waitcnt lgkmcnt(3)
    v_lshlrev_b32 v218, 16, v192
    v_mfma_f32_16x16x32_bf16 v[76:79], v[212:215], v[160:163], v[76:79]
L_pad331:
    s_cbranch_vccnz L_padret331
    v_mfma_f32_16x16x32_bf16 v[80:83], v[212:215], v[164:167], v[80:83]
    v_lshlrev_b32 v222, 16, v193
    v_lshlrev_b32 v226, 16, v194
    v_mfma_f32_16x16x32_bf16 v[84:87], v[212:215], v[168:171], v[84:87]
    v_lshlrev_b32 v230, 16, v195
    v_and_b32 v219, s55, v192
    v_mfma_f32_16x16x32_bf16 v[88:91], v[212:215], v[172:175], v[88:91]
    v_and_b32 v223, s55, v193
    v_and_b32 v227, s55, v194
    v_mfma_f32_16x16x32_bf16 v[92:95], v[212:215], v[176:179], v[92:95]
    v_and_b32 v231, s55, v195
    v_lshlrev_b32 v216, 16, v196
    v_mfma_f32_16x16x32_bf16 v[0:3], v[192:195], v[120:123], v[0:3]
    v_lshlrev_b32 v220, 16, v197
    v_lshlrev_b32 v224, 16, v198
    v_mfma_f32_16x16x32_bf16 v[4:7], v[192:195], v[124:127], v[4:7]
    v_lshlrev_b32 v228, 16, v199
    v_and_b32 v217, s55, v196
    v_mfma_f32_16x16x32_bf16 v[8:11], v[192:195], v[96:99], v[8:11]
    v_and_b32 v221, s55, v197
    v_and_b32 v225, s55, v198
    v_mfma_f32_16x16x32_bf16 v[12:15], v[192:195], v[100:103], v[12:15]
    v_and_b32 v229, s55, v199
    v_add_f32 v216, v216, v218
    v_mfma_f32_16x16x32_bf16 v[16:19], v[192:195], v[104:107], v[16:19]
    v_add_f32 v220, v220, v222
    v_add_f32 v224, v224, v226
    v_mfma_f32_16x16x32_bf16 v[20:23], v[192:195], v[108:111], v[20:23]
    v_add_f32 v228, v228, v230
    v_add_f32 v217, v217, v219
    v_mfma_f32_16x16x32_bf16 v[24:27], v[192:195], v[112:115], v[24:27]
    s_waitcnt lgkmcnt(0)
    v_add_f32 v221, v221, v223
    v_mfma_f32_16x16x32_bf16 v[28:31], v[192:195], v[116:119], v[28:31]
    v_add_f32 v225, v225, v227
    v_add_f32 v229, v229, v231
    v_mfma_f32_16x16x32_bf16 v[32:35], v[196:199], v[152:155], v[32:35]
    v_cvt_pk_bf16_f32 v208, v216, v217
    v_cvt_pk_bf16_f32 v209, v220, v221
    v_mfma_f32_16x16x32_bf16 v[36:39], v[196:199], v[156:159], v[36:39]
    v_cvt_pk_bf16_f32 v210, v224, v225
    v_cvt_pk_bf16_f32 v211, v228, v229
    v_mfma_f32_16x16x32_bf16 v[40:43], v[196:199], v[128:131], v[40:43]
    s_barrier
    v_mfma_f32_16x16x32_bf16 v[44:47], v[196:199], v[132:135], v[44:47]
    ds_read_b64_tr_b16 v[200:201], v233 offset:16384
    v_mfma_f32_16x16x32_bf16 v[48:51], v[196:199], v[136:139], v[48:51]
    ds_read_b64_tr_b16 v[202:203], v233 offset:16896
    v_mfma_f32_16x16x32_bf16 v[52:55], v[196:199], v[140:143], v[52:55]
    ds_read_b128 v[120:123], v235 offset:2880
    v_mfma_f32_16x16x32_bf16 v[56:59], v[196:199], v[144:147], v[56:59]
    ds_read_b128 v[128:131], v235 offset:19072
    v_mfma_f32_16x16x32_bf16 v[60:63], v[196:199], v[148:151], v[60:63]
    ds_read_b128 v[132:135], v235 offset:19200
    v_mfma_f32_16x16x32_bf16 v[64:67], v[208:211], v[184:187], v[64:67]
    ds_read_b128 v[184:187], v235 offset:40896
    v_mfma_f32_16x16x32_bf16 v[68:71], v[208:211], v[188:191], v[68:71]
    ds_read_b128 v[136:139], v235 offset:19328
    v_mfma_f32_16x16x32_bf16 v[72:75], v[208:211], v[160:163], v[72:75]
    ds_read_b128 v[140:143], v235 offset:19456
    v_mfma_f32_16x16x32_bf16 v[76:79], v[208:211], v[164:167], v[76:79]
    ds_read_b128 v[144:147], v235 offset:19584
    v_mfma_f32_16x16x32_bf16 v[80:83], v[208:211], v[168:171], v[80:83]
    ds_read_b128 v[148:151], v235 offset:19712
    v_mfma_f32_16x16x32_bf16 v[84:87], v[208:211], v[172:175], v[84:87]
    ds_read_b128 v[152:155], v235 offset:19840
    v_mfma_f32_16x16x32_bf16 v[88:91], v[208:211], v[176:179], v[88:91]
    s_waitcnt lgkmcnt(9)
    s_barrier
    v_mfma_f32_16x16x32_bf16 v[92:95], v[208:211], v[180:183], v[92:95]
    ds_read_b64_tr_b16 v[192:193], v233 offset:24576
    v_mfma_f32_16x16x32_bf16 v[0:3], v[200:203], v[124:127], v[0:3]
    ds_read_b64_tr_b16 v[194:195], v233 offset:25088
    v_mfma_f32_16x16x32_bf16 v[4:7], v[200:203], v[96:99], v[4:7]
    ds_read_b64_tr_b16 v[196:197], v233 offset:28672
    v_mfma_f32_16x16x32_bf16 v[8:11], v[200:203], v[100:103], v[8:11]
    ds_read_b64_tr_b16 v[198:199], v233 offset:29184
    v_mfma_f32_16x16x32_bf16 v[12:15], v[200:203], v[104:107], v[12:15]
    ds_read_b128 v[96:99], v235 offset:64
    v_mfma_f32_16x16x32_bf16 v[16:19], v[200:203], v[108:111], v[16:19]
    ds_read_b128 v[100:103], v235 offset:192
    v_mfma_f32_16x16x32_bf16 v[20:23], v[200:203], v[112:115], v[20:23]
    v_mfma_f32_16x16x32_bf16 v[24:27], v[200:203], v[116:119], v[24:27]
    s_waitcnt lgkmcnt(7)
    ds_read_b128 v[104:107], v235 offset:320
    v_mfma_f32_16x16x32_bf16 v[28:31], v[200:203], v[120:123], v[28:31]
    ds_read_b128 v[108:111], v235 offset:448
    v_mfma_f32_16x16x32_bf16 v[64:67], v[200:203], v[188:191], v[64:67]
    ds_read_b128 v[112:115], v235 offset:576
    v_mfma_f32_16x16x32_bf16 v[68:71], v[200:203], v[160:163], v[68:71]
    ds_read_b128 v[116:119], v235 offset:704
    v_mfma_f32_16x16x32_bf16 v[72:75], v[200:203], v[164:167], v[72:75]
    ds_read_b128 v[120:123], v235 offset:832
    v_mfma_f32_16x16x32_bf16 v[76:79], v[200:203], v[168:171], v[76:79]
    ds_read_b128 v[124:127], v235 offset:960
    v_mfma_f32_16x16x32_bf16 v[80:83], v[200:203], v[172:175], v[80:83]
    s_waitcnt lgkmcnt(8)
    v_lshlrev_b32 v218, 16, v192
    v_mfma_f32_16x16x32_bf16 v[84:87], v[200:203], v[176:179], v[84:87]
    v_lshlrev_b32 v222, 16, v193
    v_lshlrev_b32 v226, 16, v194
    v_mfma_f32_16x16x32_bf16 v[88:91], v[200:203], v[180:183], v[88:91]
    v_lshlrev_b32 v230, 16, v195
    v_and_b32 v219, s55, v192
    v_mfma_f32_16x16x32_bf16 v[92:95], v[200:203], v[184:187], v[92:95]
    s_waitcnt lgkmcnt(6)
    v_and_b32 v223, s55, v193
    v_mfma_f32_16x16x32_bf16 v[0:3], v[192:195], v[96:99], v[0:3]
    s_barrier
    v_mfma_f32_16x16x32_bf16 v[4:7], v[192:195], v[100:103], v[4:7]
    s_waitcnt lgkmcnt(4)
    ds_read_b64_tr_b16 v[200:201], v233 offset:32768
    v_mfma_f32_16x16x32_bf16 v[8:11], v[192:195], v[104:107], v[8:11]
    ds_read_b64_tr_b16 v[202:203], v233 offset:33280
    v_mfma_f32_16x16x32_bf16 v[12:15], v[192:195], v[108:111], v[12:15]
    s_waitcnt lgkmcnt(4)
    ds_read_b64_tr_b16 v[204:205], v233 offset:36864
    v_mfma_f32_16x16x32_bf16 v[16:19], v[192:195], v[112:115], v[16:19]
    ds_read_b64_tr_b16 v[206:207], v233 offset:37376
    v_mfma_f32_16x16x32_bf16 v[20:23], v[192:195], v[116:119], v[20:23]
    s_waitcnt lgkmcnt(4)
    v_and_b32 v227, s55, v194
    v_mfma_f32_16x16x32_bf16 v[24:27], v[192:195], v[120:123], v[24:27]
    v_and_b32 v231, s55, v195
    v_lshlrev_b32 v216, 16, v196
    v_mfma_f32_16x16x32_bf16 v[28:31], v[192:195], v[124:127], v[28:31]
    s_waitcnt lgkmcnt(2)
    v_lshlrev_b32 v220, 16, v197
    v_mfma_f32_16x16x32_bf16 v[0:3], v[200:203], v[100:103], v[0:3]
    ds_read_b128 v[96:99], v235 offset:1120
    v_mfma_f32_16x16x32_bf16 v[4:7], v[200:203], v[104:107], v[4:7]
    v_lshlrev_b32 v224, 16, v198
    v_lshlrev_b32 v228, 16, v199
    v_mfma_f32_16x16x32_bf16 v[8:11], v[200:203], v[108:111], v[8:11]
    v_and_b32 v217, s55, v196
    v_and_b32 v221, s55, v197
    v_mfma_f32_16x16x32_bf16 v[12:15], v[200:203], v[112:115], v[12:15]
    v_and_b32 v225, s55, v198
    v_and_b32 v229, s55, v199
    v_mfma_f32_16x16x32_bf16 v[16:19], v[200:203], v[116:119], v[16:19]
    v_add_f32 v216, v216, v218
    v_add_f32 v220, v220, v222
    v_mfma_f32_16x16x32_bf16 v[20:23], v[200:203], v[120:123], v[20:23]
    v_add_f32 v224, v224, v226
    v_add_f32 v228, v228, v230
    v_mfma_f32_16x16x32_bf16 v[24:27], v[200:203], v[124:127], v[24:27]
    s_waitcnt lgkmcnt(0)
    v_add_f32 v217, v217, v219
    v_mfma_f32_16x16x32_bf16 v[28:31], v[200:203], v[96:99], v[28:31]
    v_add_f32 v221, v221, v223
    v_add_f32 v225, v225, v227
    v_mfma_f32_16x16x32_bf16 v[32:35], v[196:199], v[128:131], v[32:35]
    ds_read_b128 v[156:159], v235 offset:19968
    v_mfma_f32_16x16x32_bf16 v[36:39], v[196:199], v[132:135], v[36:39]
    v_add_f32 v229, v229, v231
    v_cvt_pk_bf16_f32 v208, v216, v217
    v_mfma_f32_16x16x32_bf16 v[40:43], v[196:199], v[136:139], v[40:43]
    v_cvt_pk_bf16_f32 v209, v220, v221
    v_cvt_pk_bf16_f32 v210, v224, v225
    v_mfma_f32_16x16x32_bf16 v[44:47], v[196:199], v[140:143], v[44:47]
    v_cvt_pk_bf16_f32 v211, v228, v229
    v_lshlrev_b32 v218, 16, v200
    v_mfma_f32_16x16x32_bf16 v[48:51], v[196:199], v[144:147], v[48:51]
    v_lshlrev_b32 v222, 16, v201
    v_lshlrev_b32 v226, 16, v202
    v_mfma_f32_16x16x32_bf16 v[52:55], v[196:199], v[148:151], v[52:55]
    v_lshlrev_b32 v230, 16, v203
    v_and_b32 v219, s55, v200
    v_mfma_f32_16x16x32_bf16 v[56:59], v[196:199], v[152:155], v[56:59]
    s_waitcnt lgkmcnt(0)
    v_and_b32 v223, s55, v201
    v_mfma_f32_16x16x32_bf16 v[60:63], v[196:199], v[156:159], v[60:63]
    ds_read_b128 v[128:131], v235 offset:20128
    v_mfma_f32_16x16x32_bf16 v[32:35], v[204:207], v[132:135], v[32:35]
    v_and_b32 v227, s55, v202
    v_and_b32 v231, s55, v203
    v_mfma_f32_16x16x32_bf16 v[36:39], v[204:207], v[136:139], v[36:39]
    ds_read_b128 v[160:163], v235 offset:38080
    v_mfma_f32_16x16x32_bf16 v[40:43], v[204:207], v[140:143], v[40:43]
    ds_read_b128 v[164:167], v235 offset:38208
    v_mfma_f32_16x16x32_bf16 v[44:47], v[204:207], v[144:147], v[44:47]
    s_barrier
    ds_read_b128 v[168:171], v235 offset:38336
    v_mfma_f32_16x16x32_bf16 v[48:51], v[204:207], v[148:151], v[48:51]
    v_lshlrev_b32 v216, 16, v204
    v_lshlrev_b32 v220, 16, v205
    ds_read_b128 v[172:175], v235 offset:38464
    v_mfma_f32_16x16x32_bf16 v[52:55], v[204:207], v[152:155], v[52:55]
    v_lshlrev_b32 v224, 16, v206
    v_lshlrev_b32 v228, 16, v207
    ds_read_b128 v[176:179], v235 offset:38592
    v_mfma_f32_16x16x32_bf16 v[56:59], v[204:207], v[156:159], v[56:59]
    s_waitcnt lgkmcnt(5)
    v_and_b32 v217, s55, v204
    v_and_b32 v221, s55, v205
    ds_read_b128 v[180:183], v235 offset:38720
    v_mfma_f32_16x16x32_bf16 v[60:63], v[204:207], v[128:131], v[60:63]
    s_waitcnt lgkmcnt(5)
    v_and_b32 v225, s55, v206
    v_and_b32 v229, s55, v207
    ds_read_b64_tr_b16 v[192:193], v233 offset:40960
    ds_read_b128 v[184:187], v235 offset:38848
    v_mfma_f32_16x16x32_bf16 v[64:67], v[208:211], v[160:163], v[64:67]
    s_waitcnt lgkmcnt(6)
    v_add_f32 v216, v216, v218
    v_add_f32 v220, v220, v222
    ds_read_b64_tr_b16 v[194:195], v233 offset:41472
    ds_read_b128 v[188:191], v235 offset:38976
    v_mfma_f32_16x16x32_bf16 v[68:71], v[208:211], v[164:167], v[68:71]
    s_waitcnt lgkmcnt(7)
    v_add_f32 v224, v224, v226
    v_add_f32 v228, v228, v230
    ds_read_b64_tr_b16 v[196:197], v233 offset:45056
    v_mfma_f32_16x16x32_bf16 v[72:75], v[208:211], v[168:171], v[72:75]
    s_waitcnt lgkmcnt(7)
    v_add_f32 v217, v217, v219
    v_add_f32 v221, v221, v223
    ds_read_b64_tr_b16 v[198:199], v233 offset:45568
    v_mfma_f32_16x16x32_bf16 v[76:79], v[208:211], v[172:175], v[76:79]
    s_waitcnt lgkmcnt(7)
    v_add_f32 v225, v225, v227
    v_add_f32 v229, v229, v231
    v_mfma_f32_16x16x32_bf16 v[80:83], v[208:211], v[176:179], v[80:83]
    s_waitcnt lgkmcnt(6)
    v_cvt_pk_bf16_f32 v212, v216, v217
    v_cvt_pk_bf16_f32 v213, v220, v221
    v_mfma_f32_16x16x32_bf16 v[84:87], v[208:211], v[180:183], v[84:87]
    s_waitcnt lgkmcnt(4)
    v_cvt_pk_bf16_f32 v214, v224, v225
    v_cvt_pk_bf16_f32 v215, v228, v229
    v_mfma_f32_16x16x32_bf16 v[88:91], v[208:211], v[184:187], v[88:91]
    s_waitcnt lgkmcnt(2)
    ds_read_b128 v[160:163], v235 offset:39136
    v_mfma_f32_16x16x32_bf16 v[92:95], v[208:211], v[188:191], v[92:95]
    ds_read_b128 v[100:103], v235 offset:1248
    v_mfma_f32_16x16x32_bf16 v[64:67], v[212:215], v[164:167], v[64:67]
    ds_read_b128 v[132:135], v235 offset:20256
    v_mfma_f32_16x16x32_bf16 v[68:71], v[212:215], v[168:171], v[68:71]
    ds_read_b128 v[164:167], v235 offset:39264
    v_mfma_f32_16x16x32_bf16 v[72:75], v[212:215], v[172:175], v[72:75]
    s_waitcnt lgkmcnt(4)
    v_lshlrev_b32 v218, 16, v192
    v_mfma_f32_16x16x32_bf16 v[76:79], v[212:215], v[176:179], v[76:79]
    v_lshlrev_b32 v222, 16, v193
    v_lshlrev_b32 v226, 16, v194
    v_mfma_f32_16x16x32_bf16 v[80:83], v[212:215], v[180:183], v[80:83]
    v_lshlrev_b32 v230, 16, v195
    v_and_b32 v219, s55, v192
    v_mfma_f32_16x16x32_bf16 v[84:87], v[212:215], v[184:187], v[84:87]
    v_and_b32 v223, s55, v193
    v_and_b32 v227, s55, v194
    v_mfma_f32_16x16x32_bf16 v[88:91], v[212:215], v[188:191], v[88:91]
    s_waitcnt lgkmcnt(3)
    v_and_b32 v231, s55, v195
    v_mfma_f32_16x16x32_bf16 v[92:95], v[212:215], v[160:163], v[92:95]
    v_lshlrev_b32 v216, 16, v196
    v_lshlrev_b32 v220, 16, v197
    v_mfma_f32_16x16x32_bf16 v[0:3], v[192:195], v[104:107], v[0:3]
    v_lshlrev_b32 v224, 16, v198
    v_lshlrev_b32 v228, 16, v199
    v_mfma_f32_16x16x32_bf16 v[4:7], v[192:195], v[108:111], v[4:7]
    s_barrier
    v_mfma_f32_16x16x32_bf16 v[8:11], v[192:195], v[112:115], v[8:11]
    v_and_b32 v217, s55, v196
    v_and_b32 v221, s55, v197
    v_mfma_f32_16x16x32_bf16 v[12:15], v[192:195], v[116:119], v[12:15]
    v_and_b32 v225, s55, v198
    v_and_b32 v229, s55, v199
    v_mfma_f32_16x16x32_bf16 v[16:19], v[192:195], v[120:123], v[16:19]
    ds_read_b64_tr_b16 v[200:201], v233 offset:49152
    v_mfma_f32_16x16x32_bf16 v[20:23], v[192:195], v[124:127], v[20:23]
    v_add_f32 v216, v216, v218
    v_add_f32 v220, v220, v222
    v_mfma_f32_16x16x32_bf16 v[24:27], v[192:195], v[96:99], v[24:27]
    s_waitcnt lgkmcnt(1)
    ds_read_b64_tr_b16 v[202:203], v233 offset:49664
    v_mfma_f32_16x16x32_bf16 v[28:31], v[192:195], v[100:103], v[28:31]
    v_add_f32 v224, v224, v226
    v_add_f32 v228, v228, v230
    v_mfma_f32_16x16x32_bf16 v[32:35], v[196:199], v[136:139], v[32:35]
    ds_read_b64_tr_b16 v[204:205], v233 offset:53248
    v_mfma_f32_16x16x32_bf16 v[36:39], v[196:199], v[140:143], v[36:39]
    v_add_f32 v217, v217, v219
    v_add_f32 v221, v221, v223
    v_mfma_f32_16x16x32_bf16 v[40:43], v[196:199], v[144:147], v[40:43]
    ds_read_b64_tr_b16 v[206:207], v233 offset:53760
    v_mfma_f32_16x16x32_bf16 v[44:47], v[196:199], v[148:151], v[44:47]
    v_add_f32 v225, v225, v227
    v_add_f32 v229, v229, v231
    v_mfma_f32_16x16x32_bf16 v[48:51], v[196:199], v[152:155], v[48:51]
    v_cvt_pk_bf16_f32 v208, v216, v217
    v_cvt_pk_bf16_f32 v209, v220, v221
    v_mfma_f32_16x16x32_bf16 v[52:55], v[196:199], v[156:159], v[52:55]
    v_cvt_pk_bf16_f32 v210, v224, v225
    v_cvt_pk_bf16_f32 v211, v228, v229
    v_mfma_f32_16x16x32_bf16 v[56:59], v[196:199], v[128:131], v[56:59]
    ds_read_b128 v[104:107], v235 offset:1376
    v_mfma_f32_16x16x32_bf16 v[60:63], v[196:199], v[132:135], v[60:63]
    ds_read_b128 v[136:139], v235 offset:20384
    v_mfma_f32_16x16x32_bf16 v[64:67], v[208:211], v[168:171], v[64:67]
    ds_read_b128 v[168:171], v235 offset:39392
    v_mfma_f32_16x16x32_bf16 v[68:71], v[208:211], v[172:175], v[68:71]
    v_mfma_f32_16x16x32_bf16 v[72:75], v[208:211], v[176:179], v[72:75]
    s_waitcnt lgkmcnt(3)
    v_lshlrev_b32 v218, 16, v200
    v_mfma_f32_16x16x32_bf16 v[76:79], v[208:211], v[180:183], v[76:79]
    v_lshlrev_b32 v222, 16, v201
    v_lshlrev_b32 v226, 16, v202
    v_mfma_f32_16x16x32_bf16 v[80:83], v[208:211], v[184:187], v[80:83]
    v_lshlrev_b32 v230, 16, v203
    v_and_b32 v219, s55, v200
    v_mfma_f32_16x16x32_bf16 v[84:87], v[208:211], v[188:191], v[84:87]
    v_and_b32 v223, s55, v201
    v_and_b32 v227, s55, v202
    v_mfma_f32_16x16x32_bf16 v[88:91], v[208:211], v[160:163], v[88:91]
    v_and_b32 v231, s55, v203
    v_lshlrev_b32 v216, 16, v204
    v_mfma_f32_16x16x32_bf16 v[92:95], v[208:211], v[164:167], v[92:95]
    v_lshlrev_b32 v220, 16, v205
    v_lshlrev_b32 v224, 16, v206
    v_mfma_f32_16x16x32_bf16 v[0:3], v[200:203], v[108:111], v[0:3]
    v_lshlrev_b32 v228, 16, v207
    v_and_b32 v217, s55, v204
    v_mfma_f32_16x16x32_bf16 v[4:7], v[200:203], v[112:115], v[4:7]
    s_barrier
    v_mfma_f32_16x16x32_bf16 v[8:11], v[200:203], v[116:119], v[8:11]
    v_and_b32 v221, s55, v205
    v_and_b32 v225, s55, v206
    v_mfma_f32_16x16x32_bf16 v[12:15], v[200:203], v[120:123], v[12:15]
    v_and_b32 v229, s55, v207
    v_add_f32 v216, v216, v218
    v_mfma_f32_16x16x32_bf16 v[16:19], v[200:203], v[124:127], v[16:19]
    ds_read_b64_tr_b16 v[192:193], v234 offset:0
    v_mfma_f32_16x16x32_bf16 v[20:23], v[200:203], v[96:99], v[20:23]
    v_add_f32 v220, v220, v222
    v_add_f32 v224, v224, v226
    v_mfma_f32_16x16x32_bf16 v[24:27], v[200:203], v[100:103], v[24:27]
    s_waitcnt lgkmcnt(1)
    ds_read_b64_tr_b16 v[194:195], v234 offset:512
    v_mfma_f32_16x16x32_bf16 v[28:31], v[200:203], v[104:107], v[28:31]
    v_add_f32 v228, v228, v230
    v_add_f32 v217, v217, v219
    v_mfma_f32_16x16x32_bf16 v[32:35], v[204:207], v[140:143], v[32:35]
    ds_read_b64_tr_b16 v[196:197], v234 offset:4096
    v_mfma_f32_16x16x32_bf16 v[36:39], v[204:207], v[144:147], v[36:39]
    v_add_f32 v221, v221, v223
    v_add_f32 v225, v225, v227
    v_mfma_f32_16x16x32_bf16 v[40:43], v[204:207], v[148:151], v[40:43]
    ds_read_b64_tr_b16 v[198:199], v234 offset:4608
    v_mfma_f32_16x16x32_bf16 v[44:47], v[204:207], v[152:155], v[44:47]
    v_add_f32 v229, v229, v231
    v_cvt_pk_bf16_f32 v212, v216, v217
    v_mfma_f32_16x16x32_bf16 v[48:51], v[204:207], v[156:159], v[48:51]
    v_cvt_pk_bf16_f32 v213, v220, v221
    v_cvt_pk_bf16_f32 v214, v224, v225
    v_mfma_f32_16x16x32_bf16 v[52:55], v[204:207], v[128:131], v[52:55]
    v_cvt_pk_bf16_f32 v215, v228, v229
    v_mfma_f32_16x16x32_bf16 v[56:59], v[204:207], v[132:135], v[56:59]
    ds_read_b128 v[108:111], v235 offset:1504
    v_mfma_f32_16x16x32_bf16 v[60:63], v[204:207], v[136:139], v[60:63]
    ds_read_b128 v[140:143], v235 offset:20512
    v_mfma_f32_16x16x32_bf16 v[64:67], v[212:215], v[172:175], v[64:67]
    ds_read_b128 v[172:175], v235 offset:39520
    v_mfma_f32_16x16x32_bf16 v[68:71], v[212:215], v[176:179], v[68:71]
    v_mfma_f32_16x16x32_bf16 v[72:75], v[212:215], v[180:183], v[72:75]
    s_waitcnt lgkmcnt(3)
    v_lshlrev_b32 v218, 16, v192
    v_mfma_f32_16x16x32_bf16 v[76:79], v[212:215], v[184:187], v[76:79]
    v_lshlrev_b32 v222, 16, v193
    v_lshlrev_b32 v226, 16, v194
    v_mfma_f32_16x16x32_bf16 v[80:83], v[212:215], v[188:191], v[80:83]
    v_lshlrev_b32 v230, 16, v195
    v_and_b32 v219, s55, v192
    v_mfma_f32_16x16x32_bf16 v[84:87], v[212:215], v[160:163], v[84:87]
    v_and_b32 v223, s55, v193
    v_and_b32 v227, s55, v194
    v_mfma_f32_16x16x32_bf16 v[88:91], v[212:215], v[164:167], v[88:91]
    v_and_b32 v231, s55, v195
    v_lshlrev_b32 v216, 16, v196
    v_mfma_f32_16x16x32_bf16 v[92:95], v[212:215], v[168:171], v[92:95]
    v_lshlrev_b32 v220, 16, v197
    v_lshlrev_b32 v224, 16, v198
    v_mfma_f32_16x16x32_bf16 v[0:3], v[192:195], v[112:115], v[0:3]
    v_lshlrev_b32 v228, 16, v199
    v_and_b32 v217, s55, v196
    v_mfma_f32_16x16x32_bf16 v[4:7], v[192:195], v[116:119], v[4:7]
    s_barrier
    v_mfma_f32_16x16x32_bf16 v[8:11], v[192:195], v[120:123], v[8:11]
    v_and_b32 v221, s55, v197
    v_and_b32 v225, s55, v198
    v_mfma_f32_16x16x32_bf16 v[12:15], v[192:195], v[124:127], v[12:15]
    v_and_b32 v229, s55, v199
    v_add_f32 v216, v216, v218
    v_mfma_f32_16x16x32_bf16 v[16:19], v[192:195], v[96:99], v[16:19]
    ds_read_b64_tr_b16 v[200:201], v234 offset:8192
    v_mfma_f32_16x16x32_bf16 v[20:23], v[192:195], v[100:103], v[20:23]
    v_add_f32 v220, v220, v222
    v_add_f32 v224, v224, v226
    v_mfma_f32_16x16x32_bf16 v[24:27], v[192:195], v[104:107], v[24:27]
    s_waitcnt lgkmcnt(1)
    ds_read_b64_tr_b16 v[202:203], v234 offset:8704
    v_mfma_f32_16x16x32_bf16 v[28:31], v[192:195], v[108:111], v[28:31]
    v_add_f32 v228, v228, v230
    v_add_f32 v217, v217, v219
    v_mfma_f32_16x16x32_bf16 v[32:35], v[196:199], v[144:147], v[32:35]
    ds_read_b64_tr_b16 v[204:205], v234 offset:12288
    v_mfma_f32_16x16x32_bf16 v[36:39], v[196:199], v[148:151], v[36:39]
    v_add_f32 v221, v221, v223
    v_add_f32 v225, v225, v227
    v_mfma_f32_16x16x32_bf16 v[40:43], v[196:199], v[152:155], v[40:43]
    ds_read_b64_tr_b16 v[206:207], v234 offset:12800
    v_mfma_f32_16x16x32_bf16 v[44:47], v[196:199], v[156:159], v[44:47]
    v_add_f32 v229, v229, v231
    v_cvt_pk_bf16_f32 v208, v216, v217
    v_mfma_f32_16x16x32_bf16 v[48:51], v[196:199], v[128:131], v[48:51]
    v_cvt_pk_bf16_f32 v209, v220, v221
    v_cvt_pk_bf16_f32 v210, v224, v225
    v_mfma_f32_16x16x32_bf16 v[52:55], v[196:199], v[132:135], v[52:55]
    v_cvt_pk_bf16_f32 v211, v228, v229
    v_mfma_f32_16x16x32_bf16 v[56:59], v[196:199], v[136:139], v[56:59]
    ds_read_b128 v[112:115], v235 offset:1632
    v_mfma_f32_16x16x32_bf16 v[60:63], v[196:199], v[140:143], v[60:63]
    ds_read_b128 v[144:147], v235 offset:20640
    v_mfma_f32_16x16x32_bf16 v[64:67], v[208:211], v[176:179], v[64:67]
    ds_read_b128 v[176:179], v235 offset:39648
    v_mfma_f32_16x16x32_bf16 v[68:71], v[208:211], v[180:183], v[68:71]
    v_mfma_f32_16x16x32_bf16 v[72:75], v[208:211], v[184:187], v[72:75]
    s_waitcnt lgkmcnt(3)
    v_lshlrev_b32 v218, 16, v200
    v_mfma_f32_16x16x32_bf16 v[76:79], v[208:211], v[188:191], v[76:79]
    v_lshlrev_b32 v222, 16, v201
    v_lshlrev_b32 v226, 16, v202
    v_mfma_f32_16x16x32_bf16 v[80:83], v[208:211], v[160:163], v[80:83]
    v_lshlrev_b32 v230, 16, v203
    v_and_b32 v219, s55, v200
    v_mfma_f32_16x16x32_bf16 v[84:87], v[208:211], v[164:167], v[84:87]
    v_and_b32 v223, s55, v201
    v_and_b32 v227, s55, v202
    v_mfma_f32_16x16x32_bf16 v[88:91], v[208:211], v[168:171], v[88:91]
    v_and_b32 v231, s55, v203
    v_lshlrev_b32 v216, 16, v204
    v_mfma_f32_16x16x32_bf16 v[92:95], v[208:211], v[172:175], v[92:95]
    v_lshlrev_b32 v220, 16, v205
    v_lshlrev_b32 v224, 16, v206
    v_mfma_f32_16x16x32_bf16 v[0:3], v[200:203], v[116:119], v[0:3]
    v_lshlrev_b32 v228, 16, v207
    v_and_b32 v217, s55, v204
    v_mfma_f32_16x16x32_bf16 v[4:7], v[200:203], v[120:123], v[4:7]
    s_barrier
    v_mfma_f32_16x16x32_bf16 v[8:11], v[200:203], v[124:127], v[8:11]
    v_and_b32 v221, s55, v205
    v_and_b32 v225, s55, v206
    v_mfma_f32_16x16x32_bf16 v[12:15], v[200:203], v[96:99], v[12:15]
    v_and_b32 v229, s55, v207
    v_add_f32 v216, v216, v218
    v_mfma_f32_16x16x32_bf16 v[16:19], v[200:203], v[100:103], v[16:19]
    ds_read_b64_tr_b16 v[192:193], v234 offset:16384
    v_mfma_f32_16x16x32_bf16 v[20:23], v[200:203], v[104:107], v[20:23]
    v_add_f32 v220, v220, v222
    v_add_f32 v224, v224, v226
    v_mfma_f32_16x16x32_bf16 v[24:27], v[200:203], v[108:111], v[24:27]
    s_waitcnt lgkmcnt(1)
    ds_read_b64_tr_b16 v[194:195], v234 offset:16896
    v_mfma_f32_16x16x32_bf16 v[28:31], v[200:203], v[112:115], v[28:31]
    v_add_f32 v228, v228, v230
    v_add_f32 v217, v217, v219
    v_mfma_f32_16x16x32_bf16 v[32:35], v[204:207], v[148:151], v[32:35]
    ds_read_b64_tr_b16 v[196:197], v234 offset:20480
    v_mfma_f32_16x16x32_bf16 v[36:39], v[204:207], v[152:155], v[36:39]
    v_add_f32 v221, v221, v223
    v_add_f32 v225, v225, v227
    v_mfma_f32_16x16x32_bf16 v[40:43], v[204:207], v[156:159], v[40:43]
    ds_read_b64_tr_b16 v[198:199], v234 offset:20992
    v_mfma_f32_16x16x32_bf16 v[44:47], v[204:207], v[128:131], v[44:47]
    v_add_f32 v229, v229, v231
    v_cvt_pk_bf16_f32 v212, v216, v217
    v_mfma_f32_16x16x32_bf16 v[48:51], v[204:207], v[132:135], v[48:51]
    v_cvt_pk_bf16_f32 v213, v220, v221
    v_cvt_pk_bf16_f32 v214, v224, v225
    v_mfma_f32_16x16x32_bf16 v[52:55], v[204:207], v[136:139], v[52:55]
    v_cvt_pk_bf16_f32 v215, v228, v229
    v_mfma_f32_16x16x32_bf16 v[56:59], v[204:207], v[140:143], v[56:59]
    ds_read_b128 v[116:119], v235 offset:1760
    v_mfma_f32_16x16x32_bf16 v[60:63], v[204:207], v[144:147], v[60:63]
    ds_read_b128 v[148:151], v235 offset:20768
    v_mfma_f32_16x16x32_bf16 v[64:67], v[212:215], v[180:183], v[64:67]
    ds_read_b128 v[180:183], v235 offset:39776
    v_mfma_f32_16x16x32_bf16 v[68:71], v[212:215], v[184:187], v[68:71]
    v_mfma_f32_16x16x32_bf16 v[72:75], v[212:215], v[188:191], v[72:75]
    s_waitcnt lgkmcnt(3)
    v_lshlrev_b32 v218, 16, v192
    v_mfma_f32_16x16x32_bf16 v[76:79], v[212:215], v[160:163], v[76:79]
    v_lshlrev_b32 v222, 16, v193
    v_lshlrev_b32 v226, 16, v194
    v_mfma_f32_16x16x32_bf16 v[80:83], v[212:215], v[164:167], v[80:83]
    v_lshlrev_b32 v230, 16, v195
    v_and_b32 v219, s55, v192
    v_mfma_f32_16x16x32_bf16 v[84:87], v[212:215], v[168:171], v[84:87]
    v_and_b32 v223, s55, v193
    v_and_b32 v227, s55, v194
    v_mfma_f32_16x16x32_bf16 v[88:91], v[212:215], v[172:175], v[88:91]
    v_and_b32 v231, s55, v195
    v_lshlrev_b32 v216, 16, v196
    v_mfma_f32_16x16x32_bf16 v[92:95], v[212:215], v[176:179], v[92:95]
    v_lshlrev_b32 v220, 16, v197
    v_lshlrev_b32 v224, 16, v198
    v_mfma_f32_16x16x32_bf16 v[0:3], v[192:195], v[120:123], v[0:3]
    v_lshlrev_b32 v228, 16, v199
    v_and_b32 v217, s55, v196
    v_mfma_f32_16x16x32_bf16 v[4:7], v[192:195], v[124:127], v[4:7]
    s_barrier
    v_mfma_f32_16x16x32_bf16 v[8:11], v[192:195], v[96:99], v[8:11]
    v_and_b32 v221, s55, v197
    v_and_b32 v225, s55, v198
    v_mfma_f32_16x16x32_bf16 v[12:15], v[192:195], v[100:103], v[12:15]
    v_and_b32 v229, s55, v199
    v_add_f32 v216, v216, v218
    v_mfma_f32_16x16x32_bf16 v[16:19], v[192:195], v[104:107], v[16:19]
    ds_read_b64_tr_b16 v[200:201], v234 offset:24576
    v_mfma_f32_16x16x32_bf16 v[20:23], v[192:195], v[108:111], v[20:23]
    v_add_f32 v220, v220, v222
    v_add_f32 v224, v224, v226
    v_mfma_f32_16x16x32_bf16 v[24:27], v[192:195], v[112:115], v[24:27]
    s_waitcnt lgkmcnt(1)
    ds_read_b64_tr_b16 v[202:203], v234 offset:25088
    v_mfma_f32_16x16x32_bf16 v[28:31], v[192:195], v[116:119], v[28:31]
    v_add_f32 v228, v228, v230
    v_add_f32 v217, v217, v219
    v_mfma_f32_16x16x32_bf16 v[32:35], v[196:199], v[152:155], v[32:35]
    ds_read_b64_tr_b16 v[204:205], v234 offset:28672
    v_mfma_f32_16x16x32_bf16 v[36:39], v[196:199], v[156:159], v[36:39]
    v_add_f32 v221, v221, v223
    v_add_f32 v225, v225, v227
    v_mfma_f32_16x16x32_bf16 v[40:43], v[196:199], v[128:131], v[40:43]
    ds_read_b64_tr_b16 v[206:207], v234 offset:29184
    v_mfma_f32_16x16x32_bf16 v[44:47], v[196:199], v[132:135], v[44:47]
    v_add_f32 v229, v229, v231
    v_cvt_pk_bf16_f32 v208, v216, v217
    v_mfma_f32_16x16x32_bf16 v[48:51], v[196:199], v[136:139], v[48:51]
    v_cvt_pk_bf16_f32 v209, v220, v221
    v_cvt_pk_bf16_f32 v210, v224, v225
    v_mfma_f32_16x16x32_bf16 v[52:55], v[196:199], v[140:143], v[52:55]
    v_cvt_pk_bf16_f32 v211, v228, v229
    v_mfma_f32_16x16x32_bf16 v[56:59], v[196:199], v[144:147], v[56:59]
    ds_read_b128 v[120:123], v235 offset:1888
    v_mfma_f32_16x16x32_bf16 v[60:63], v[196:199], v[148:151], v[60:63]
    ds_read_b128 v[152:155], v235 offset:20896
    v_mfma_f32_16x16x32_bf16 v[64:67], v[208:211], v[184:187], v[64:67]
    ds_read_b128 v[184:187], v235 offset:39904
    v_mfma_f32_16x16x32_bf16 v[68:71], v[208:211], v[188:191], v[68:71]
    v_mfma_f32_16x16x32_bf16 v[72:75], v[208:211], v[160:163], v[72:75]
    s_waitcnt lgkmcnt(3)
    v_lshlrev_b32 v218, 16, v200
    v_mfma_f32_16x16x32_bf16 v[76:79], v[208:211], v[164:167], v[76:79]
    v_lshlrev_b32 v222, 16, v201
    v_lshlrev_b32 v226, 16, v202
    v_mfma_f32_16x16x32_bf16 v[80:83], v[208:211], v[168:171], v[80:83]
    v_lshlrev_b32 v230, 16, v203
    v_and_b32 v219, s55, v200
    v_mfma_f32_16x16x32_bf16 v[84:87], v[208:211], v[172:175], v[84:87]
    v_and_b32 v223, s55, v201
    v_and_b32 v227, s55, v202
    v_mfma_f32_16x16x32_bf16 v[88:91], v[208:211], v[176:179], v[88:91]
    v_and_b32 v231, s55, v203
    v_lshlrev_b32 v216, 16, v204
    v_mfma_f32_16x16x32_bf16 v[92:95], v[208:211], v[180:183], v[92:95]
    v_lshlrev_b32 v220, 16, v205
    v_lshlrev_b32 v224, 16, v206
    v_mfma_f32_16x16x32_bf16 v[0:3], v[200:203], v[124:127], v[0:3]
    v_lshlrev_b32 v228, 16, v207
    v_and_b32 v217, s55, v204
    v_mfma_f32_16x16x32_bf16 v[4:7], v[200:203], v[96:99], v[4:7]
    s_barrier
    v_mfma_f32_16x16x32_bf16 v[8:11], v[200:203], v[100:103], v[8:11]
    v_and_b32 v221, s55, v205
    v_and_b32 v225, s55, v206
    v_mfma_f32_16x16x32_bf16 v[12:15], v[200:203], v[104:107], v[12:15]
    v_and_b32 v229, s55, v207
    v_add_f32 v216, v216, v218
    v_mfma_f32_16x16x32_bf16 v[16:19], v[200:203], v[108:111], v[16:19]
    ds_read_b64_tr_b16 v[192:193], v234 offset:32768
    v_mfma_f32_16x16x32_bf16 v[20:23], v[200:203], v[112:115], v[20:23]
    v_add_f32 v220, v220, v222
    v_add_f32 v224, v224, v226
    v_mfma_f32_16x16x32_bf16 v[24:27], v[200:203], v[116:119], v[24:27]
    s_waitcnt lgkmcnt(1)
    ds_read_b64_tr_b16 v[194:195], v234 offset:33280
    v_mfma_f32_16x16x32_bf16 v[28:31], v[200:203], v[120:123], v[28:31]
    v_add_f32 v228, v228, v230
    v_add_f32 v217, v217, v219
    v_mfma_f32_16x16x32_bf16 v[32:35], v[204:207], v[156:159], v[32:35]
    ds_read_b64_tr_b16 v[196:197], v234 offset:36864
    v_mfma_f32_16x16x32_bf16 v[36:39], v[204:207], v[128:131], v[36:39]
    v_add_f32 v221, v221, v223
    v_add_f32 v225, v225, v227
    v_mfma_f32_16x16x32_bf16 v[40:43], v[204:207], v[132:135], v[40:43]
    ds_read_b64_tr_b16 v[198:199], v234 offset:37376
    v_mfma_f32_16x16x32_bf16 v[44:47], v[204:207], v[136:139], v[44:47]
    v_add_f32 v229, v229, v231
    v_cvt_pk_bf16_f32 v212, v216, v217
    v_mfma_f32_16x16x32_bf16 v[48:51], v[204:207], v[140:143], v[48:51]
    v_cvt_pk_bf16_f32 v213, v220, v221
    v_cvt_pk_bf16_f32 v214, v224, v225
    v_mfma_f32_16x16x32_bf16 v[52:55], v[204:207], v[144:147], v[52:55]
    v_cvt_pk_bf16_f32 v215, v228, v229
    v_mfma_f32_16x16x32_bf16 v[56:59], v[204:207], v[148:151], v[56:59]
    ds_read_b128 v[124:127], v235 offset:2016
    v_mfma_f32_16x16x32_bf16 v[60:63], v[204:207], v[152:155], v[60:63]
    ds_read_b128 v[156:159], v235 offset:21024
    v_mfma_f32_16x16x32_bf16 v[64:67], v[212:215], v[188:191], v[64:67]
    ds_read_b128 v[188:191], v235 offset:40032
    v_mfma_f32_16x16x32_bf16 v[68:71], v[212:215], v[160:163], v[68:71]
    v_mfma_f32_16x16x32_bf16 v[72:75], v[212:215], v[164:167], v[72:75]
    s_waitcnt lgkmcnt(3)
    v_lshlrev_b32 v218, 16, v192
    v_mfma_f32_16x16x32_bf16 v[76:79], v[212:215], v[168:171], v[76:79]
    v_lshlrev_b32 v222, 16, v193
    v_lshlrev_b32 v226, 16, v194
    v_mfma_f32_16x16x32_bf16 v[80:83], v[212:215], v[172:175], v[80:83]
    v_lshlrev_b32 v230, 16, v195
    v_and_b32 v219, s55, v192
    v_mfma_f32_16x16x32_bf16 v[84:87], v[212:215], v[176:179], v[84:87]
    v_and_b32 v223, s55, v193
    v_and_b32 v227, s55, v194
    v_mfma_f32_16x16x32_bf16 v[88:91], v[212:215], v[180:183], v[88:91]
    v_and_b32 v231, s55, v195
    v_lshlrev_b32 v216, 16, v196
    v_mfma_f32_16x16x32_bf16 v[92:95], v[212:215], v[184:187], v[92:95]
    v_lshlrev_b32 v220, 16, v197
    v_lshlrev_b32 v224, 16, v198
    v_mfma_f32_16x16x32_bf16 v[0:3], v[192:195], v[96:99], v[0:3]
    v_lshlrev_b32 v228, 16, v199
    v_and_b32 v217, s55, v196
    v_mfma_f32_16x16x32_bf16 v[4:7], v[192:195], v[100:103], v[4:7]
    s_barrier
    v_mfma_f32_16x16x32_bf16 v[8:11], v[192:195], v[104:107], v[8:11]
    v_and_b32 v221, s55, v197
    v_and_b32 v225, s55, v198
    v_mfma_f32_16x16x32_bf16 v[12:15], v[192:195], v[108:111], v[12:15]
    v_and_b32 v229, s55, v199
    v_add_f32 v216, v216, v218
    v_mfma_f32_16x16x32_bf16 v[16:19], v[192:195], v[112:115], v[16:19]
    ds_read_b64_tr_b16 v[200:201], v234 offset:40960
    v_mfma_f32_16x16x32_bf16 v[20:23], v[192:195], v[116:119], v[20:23]
    v_add_f32 v220, v220, v222
    v_add_f32 v224, v224, v226
    v_mfma_f32_16x16x32_bf16 v[24:27], v[192:195], v[120:123], v[24:27]
    s_waitcnt lgkmcnt(1)
    ds_read_b64_tr_b16 v[202:203], v234 offset:41472
    v_mfma_f32_16x16x32_bf16 v[28:31], v[192:195], v[124:127], v[28:31]
    v_add_f32 v228, v228, v230
    v_add_f32 v217, v217, v219
    v_mfma_f32_16x16x32_bf16 v[32:35], v[196:199], v[128:131], v[32:35]
L_pad576:
    s_cbranch_vccnz L_padret576
    v_mfma_f32_16x16x32_bf16 v[36:39], v[196:199], v[132:135], v[36:39]
    ds_read_b64_tr_b16 v[204:205], v234 offset:45056
    v_mfma_f32_16x16x32_bf16 v[40:43], v[196:199], v[136:139], v[40:43]
    v_add_f32 v221, v221, v223
    ds_read_b64_tr_b16 v[206:207], v234 offset:45568
    v_mfma_f32_16x16x32_bf16 v[44:47], v[196:199], v[140:143], v[44:47]
    v_add_f32 v225, v225, v227
    v_add_f32 v229, v229, v231
    v_mfma_f32_16x16x32_bf16 v[48:51], v[196:199], v[144:147], v[48:51]
    v_cvt_pk_bf16_f32 v208, v216, v217
    v_cvt_pk_bf16_f32 v209, v220, v221
    v_mfma_f32_16x16x32_bf16 v[52:55], v[196:199], v[148:151], v[52:55]
    v_cvt_pk_bf16_f32 v210, v224, v225
    v_cvt_pk_bf16_f32 v211, v228, v229
    v_mfma_f32_16x16x32_bf16 v[56:59], v[196:199], v[152:155], v[56:59]
    ds_read_b128 v[96:99], v235 offset:2176
    v_mfma_f32_16x16x32_bf16 v[60:63], v[196:199], v[156:159], v[60:63]
    ds_read_b128 v[128:131], v235 offset:21184
    v_mfma_f32_16x16x32_bf16 v[64:67], v[208:211], v[160:163], v[64:67]
    ds_read_b128 v[160:163], v235 offset:40192
    v_mfma_f32_16x16x32_bf16 v[68:71], v[208:211], v[164:167], v[68:71]
    v_mfma_f32_16x16x32_bf16 v[72:75], v[208:211], v[168:171], v[72:75]
    s_waitcnt lgkmcnt(3)
    v_lshlrev_b32 v218, 16, v200
    v_mfma_f32_16x16x32_bf16 v[76:79], v[208:211], v[172:175], v[76:79]
    v_lshlrev_b32 v222, 16, v201
    v_lshlrev_b32 v226, 16, v202
    v_mfma_f32_16x16x32_bf16 v[80:83], v[208:211], v[176:179], v[80:83]
    v_lshlrev_b32 v230, 16, v203
    v_and_b32 v219, s55, v200
    v_mfma_f32_16x16x32_bf16 v[84:87], v[208:211], v[180:183], v[84:87]
    v_and_b32 v223, s55, v201
    v_and_b32 v227, s55, v202
    v_mfma_f32_16x16x32_bf16 v[88:91], v[208:211], v[184:187], v[88:91]
    v_and_b32 v231, s55, v203
    v_lshlrev_b32 v216, 16, v204
    v_mfma_f32_16x16x32_bf16 v[92:95], v[208:211], v[188:191], v[92:95]
    v_lshlrev_b32 v220, 16, v205
    v_lshlrev_b32 v224, 16, v206
    v_mfma_f32_16x16x32_bf16 v[0:3], v[200:203], v[100:103], v[0:3]
    v_lshlrev_b32 v228, 16, v207
    v_and_b32 v217, s55, v204
    v_mfma_f32_16x16x32_bf16 v[4:7], v[200:203], v[104:107], v[4:7]
    s_barrier
    v_mfma_f32_16x16x32_bf16 v[8:11], v[200:203], v[108:111], v[8:11]
    v_and_b32 v221, s55, v205
    v_and_b32 v225, s55, v206
    v_mfma_f32_16x16x32_bf16 v[12:15], v[200:203], v[112:115], v[12:15]
    v_and_b32 v229, s55, v207
    v_add_f32 v216, v216, v218
    v_mfma_f32_16x16x32_bf16 v[16:19], v[200:203], v[116:119], v[16:19]
    ds_read_b64_tr_b16 v[192:193], v233 offset:0
    v_mfma_f32_16x16x32_bf16 v[20:23], v[200:203], v[120:123], v[20:23]
    v_add_f32 v220, v220, v222
    v_add_f32 v224, v224, v226
    v_mfma_f32_16x16x32_bf16 v[24:27], v[200:203], v[124:127], v[24:27]
    s_waitcnt lgkmcnt(1)
    ds_read_b64_tr_b16 v[194:195], v233 offset:512
    v_mfma_f32_16x16x32_bf16 v[28:31], v[200:203], v[96:99], v[28:31]
    v_add_f32 v228, v228, v230
    v_add_f32 v217, v217, v219
    v_mfma_f32_16x16x32_bf16 v[32:35], v[204:207], v[132:135], v[32:35]
    ds_read_b64_tr_b16 v[196:197], v233 offset:4096
    v_mfma_f32_16x16x32_bf16 v[36:39], v[204:207], v[136:139], v[36:39]
    v_add_f32 v221, v221, v223
    v_add_f32 v225, v225, v227
    v_mfma_f32_16x16x32_bf16 v[40:43], v[204:207], v[140:143], v[40:43]
    ds_read_b64_tr_b16 v[198:199], v233 offset:4608
    v_mfma_f32_16x16x32_bf16 v[44:47], v[204:207], v[144:147], v[44:47]
    v_add_f32 v229, v229, v231
    v_cvt_pk_bf16_f32 v212, v216, v217
    v_mfma_f32_16x16x32_bf16 v[48:51], v[204:207], v[148:151], v[48:51]
    v_cvt_pk_bf16_f32 v213, v220, v221
    v_cvt_pk_bf16_f32 v214, v224, v225
    v_mfma_f32_16x16x32_bf16 v[52:55], v[204:207], v[152:155], v[52:55]
    v_cvt_pk_bf16_f32 v215, v228, v229
    v_mfma_f32_16x16x32_bf16 v[56:59], v[204:207], v[156:159], v[56:59]
    ds_read_b128 v[100:103], v235 offset:2304
    v_mfma_f32_16x16x32_bf16 v[60:63], v[204:207], v[128:131], v[60:63]
    ds_read_b128 v[132:135], v235 offset:21312
    v_mfma_f32_16x16x32_bf16 v[64:67], v[212:215], v[164:167], v[64:67]
    ds_read_b128 v[164:167], v235 offset:40320
    v_mfma_f32_16x16x32_bf16 v[68:71], v[212:215], v[168:171], v[68:71]
    v_mfma_f32_16x16x32_bf16 v[72:75], v[212:215], v[172:175], v[72:75]
    s_waitcnt lgkmcnt(3)
    v_lshlrev_b32 v218, 16, v192
    v_mfma_f32_16x16x32_bf16 v[76:79], v[212:215], v[176:179], v[76:79]
    v_lshlrev_b32 v222, 16, v193
    v_lshlrev_b32 v226, 16, v194
    v_mfma_f32_16x16x32_bf16 v[80:83], v[212:215], v[180:183], v[80:83]
    v_lshlrev_b32 v230, 16, v195
    v_and_b32 v219, s55, v192
    v_mfma_f32_16x16x32_bf16 v[84:87], v[212:215], v[184:187], v[84:87]
    v_and_b32 v223, s55, v193
    v_and_b32 v227, s55, v194
    v_mfma_f32_16x16x32_bf16 v[88:91], v[212:215], v[188:191], v[88:91]
    v_and_b32 v231, s55, v195
    v_lshlrev_b32 v216, 16, v196
    v_mfma_f32_16x16x32_bf16 v[92:95], v[212:215], v[160:163], v[92:95]
    v_lshlrev_b32 v220, 16, v197
    v_lshlrev_b32 v224, 16, v198
    v_mfma_f32_16x16x32_bf16 v[0:3], v[192:195], v[104:107], v[0:3]
    v_lshlrev_b32 v228, 16, v199
    v_and_b32 v217, s55, v196
    v_mfma_f32_16x16x32_bf16 v[4:7], v[192:195], v[108:111], v[4:7]
    s_barrier
    v_mfma_f32_16x16x32_bf16 v[8:11], v[192:195], v[112:115], v[8:11]
    v_and_b32 v221, s55, v197
    v_and_b32 v225, s55, v198
    v_mfma_f32_16x16x32_bf16 v[12:15], v[192:195], v[116:119], v[12:15]
    v_and_b32 v229, s55, v199
    v_add_f32 v216, v216, v218
    v_mfma_f32_16x16x32_bf16 v[16:19], v[192:195], v[120:123], v[16:19]
    ds_read_b64_tr_b16 v[200:201], v233 offset:8192
    v_mfma_f32_16x16x32_bf16 v[20:23], v[192:195], v[124:127], v[20:23]
    v_add_f32 v220, v220, v222
    v_add_f32 v224, v224, v226
    v_mfma_f32_16x16x32_bf16 v[24:27], v[192:195], v[96:99], v[24:27]
    s_waitcnt lgkmcnt(1)
    ds_read_b64_tr_b16 v[202:203], v233 offset:8704
    v_mfma_f32_16x16x32_bf16 v[28:31], v[192:195], v[100:103], v[28:31]
    v_add_f32 v228, v228, v230
    v_add_f32 v217, v217, v219
    v_mfma_f32_16x16x32_bf16 v[32:35], v[196:199], v[136:139], v[32:35]
    ds_read_b64_tr_b16 v[204:205], v233 offset:12288
    v_mfma_f32_16x16x32_bf16 v[36:39], v[196:199], v[140:143], v[36:39]
    v_add_f32 v221, v221, v223
    v_add_f32 v225, v225, v227
    v_mfma_f32_16x16x32_bf16 v[40:43], v[196:199], v[144:147], v[40:43]
    ds_read_b64_tr_b16 v[206:207], v233 offset:12800
    v_mfma_f32_16x16x32_bf16 v[44:47], v[196:199], v[148:151], v[44:47]
    v_add_f32 v229, v229, v231
    v_cvt_pk_bf16_f32 v208, v216, v217
    v_mfma_f32_16x16x32_bf16 v[48:51], v[196:199], v[152:155], v[48:51]
    v_cvt_pk_bf16_f32 v209, v220, v221
    v_cvt_pk_bf16_f32 v210, v224, v225
    v_mfma_f32_16x16x32_bf16 v[52:55], v[196:199], v[156:159], v[52:55]
    v_cvt_pk_bf16_f32 v211, v228, v229
    v_mfma_f32_16x16x32_bf16 v[56:59], v[196:199], v[128:131], v[56:59]
    ds_read_b128 v[104:107], v235 offset:2432
    v_mfma_f32_16x16x32_bf16 v[60:63], v[196:199], v[132:135], v[60:63]
    ds_read_b128 v[136:139], v235 offset:21440
    v_mfma_f32_16x16x32_bf16 v[64:67], v[208:211], v[168:171], v[64:67]
    ds_read_b128 v[168:171], v235 offset:40448
    v_mfma_f32_16x16x32_bf16 v[68:71], v[208:211], v[172:175], v[68:71]
    v_mfma_f32_16x16x32_bf16 v[72:75], v[208:211], v[176:179], v[72:75]
    s_waitcnt lgkmcnt(3)
    v_lshlrev_b32 v218, 16, v200
    v_mfma_f32_16x16x32_bf16 v[76:79], v[208:211], v[180:183], v[76:79]
    v_lshlrev_b32 v222, 16, v201
    v_lshlrev_b32 v226, 16, v202
    v_mfma_f32_16x16x32_bf16 v[80:83], v[208:211], v[184:187], v[80:83]
    v_lshlrev_b32 v230, 16, v203
    v_and_b32 v219, s55, v200
    v_mfma_f32_16x16x32_bf16 v[84:87], v[208:211], v[188:191], v[84:87]
    v_and_b32 v223, s55, v201
    v_and_b32 v227, s55, v202
    v_mfma_f32_16x16x32_bf16 v[88:91], v[208:211], v[160:163], v[88:91]
    v_and_b32 v231, s55, v203
    v_lshlrev_b32 v216, 16, v204
    v_mfma_f32_16x16x32_bf16 v[92:95], v[208:211], v[164:167], v[92:95]
    v_lshlrev_b32 v220, 16, v205
    v_lshlrev_b32 v224, 16, v206
    v_mfma_f32_16x16x32_bf16 v[0:3], v[200:203], v[108:111], v[0:3]
    v_lshlrev_b32 v228, 16, v207
    v_and_b32 v217, s55, v204
    v_mfma_f32_16x16x32_bf16 v[4:7], v[200:203], v[112:115], v[4:7]
    s_barrier
    v_mfma_f32_16x16x32_bf16 v[8:11], v[200:203], v[116:119], v[8:11]
    v_and_b32 v221, s55, v205
    v_and_b32 v225, s55, v206
    v_mfma_f32_16x16x32_bf16 v[12:15], v[200:203], v[120:123], v[12:15]
    v_and_b32 v229, s55, v207
    v_add_f32 v216, v216, v218
    v_mfma_f32_16x16x32_bf16 v[16:19], v[200:203], v[124:127], v[16:19]
    ds_read_b64_tr_b16 v[192:193], v233 offset:16384
    v_mfma_f32_16x16x32_bf16 v[20:23], v[200:203], v[96:99], v[20:23]
    v_add_f32 v220, v220, v222
    v_add_f32 v224, v224, v226
    v_mfma_f32_16x16x32_bf16 v[24:27], v[200:203], v[100:103], v[24:27]
    s_waitcnt lgkmcnt(1)
    ds_read_b64_tr_b16 v[194:195], v233 offset:16896
    v_mfma_f32_16x16x32_bf16 v[28:31], v[200:203], v[104:107], v[28:31]
    v_add_f32 v228, v228, v230
    v_add_f32 v217, v217, v219
    v_mfma_f32_16x16x32_bf16 v[32:35], v[204:207], v[140:143], v[32:35]
    ds_read_b64_tr_b16 v[196:197], v233 offset:20480
    v_mfma_f32_16x16x32_bf16 v[36:39], v[204:207], v[144:147], v[36:39]
    v_add_f32 v221, v221, v223
    v_add_f32 v225, v225, v227
    v_mfma_f32_16x16x32_bf16 v[40:43], v[204:207], v[148:151], v[40:43]
    ds_read_b64_tr_b16 v[198:199], v233 offset:20992
    v_mfma_f32_16x16x32_bf16 v[44:47], v[204:207], v[152:155], v[44:47]
    v_add_f32 v229, v229, v231
    v_cvt_pk_bf16_f32 v212, v216, v217
    v_mfma_f32_16x16x32_bf16 v[48:51], v[204:207], v[156:159], v[48:51]
    v_cvt_pk_bf16_f32 v213, v220, v221
    v_cvt_pk_bf16_f32 v214, v224, v225
    v_mfma_f32_16x16x32_bf16 v[52:55], v[204:207], v[128:131], v[52:55]
    v_cvt_pk_bf16_f32 v215, v228, v229
    v_mfma_f32_16x16x32_bf16 v[56:59], v[204:207], v[132:135], v[56:59]
    ds_read_b128 v[108:111], v235 offset:2560
    v_mfma_f32_16x16x32_bf16 v[60:63], v[204:207], v[136:139], v[60:63]
    ds_read_b128 v[140:143], v235 offset:21568
    v_mfma_f32_16x16x32_bf16 v[64:67], v[212:215], v[172:175], v[64:67]
    ds_read_b128 v[172:175], v235 offset:40576
    v_mfma_f32_16x16x32_bf16 v[68:71], v[212:215], v[176:179], v[68:71]
    v_mfma_f32_16x16x32_bf16 v[72:75], v[212:215], v[180:183], v[72:75]
    s_waitcnt lgkmcnt(3)
    v_lshlrev_b32 v218, 16, v192
    v_mfma_f32_16x16x32_bf16 v[76:79], v[212:215], v[184:187], v[76:79]
    v_lshlrev_b32 v222, 16, v193
    v_lshlrev_b32 v226, 16, v194
    v_mfma_f32_16x16x32_bf16 v[80:83], v[212:215], v[188:191], v[80:83]
    v_lshlrev_b32 v230, 16, v195
    v_and_b32 v219, s55, v192
    v_mfma_f32_16x16x32_bf16 v[84:87], v[212:215], v[160:163], v[84:87]
    v_and_b32 v223, s55, v193
    v_and_b32 v227, s55, v194
    v_mfma_f32_16x16x32_bf16 v[88:91], v[212:215], v[164:167], v[88:91]
    v_and_b32 v231, s55, v195
    v_lshlrev_b32 v216, 16, v196
    v_mfma_f32_16x16x32_bf16 v[92:95], v[212:215], v[168:171], v[92:95]
    v_lshlrev_b32 v220, 16, v197
    v_lshlrev_b32 v224, 16, v198
    v_mfma_f32_16x16x32_bf16 v[0:3], v[192:195], v[112:115], v[0:3]
    v_lshlrev_b32 v228, 16, v199
    v_and_b32 v217, s55, v196
    v_mfma_f32_16x16x32_bf16 v[4:7], v[192:195], v[116:119], v[4:7]
    s_barrier
    v_mfma_f32_16x16x32_bf16 v[8:11], v[192:195], v[120:123], v[8:11]
    v_and_b32 v221, s55, v197
    v_and_b32 v225, s55, v198
    v_mfma_f32_16x16x32_bf16 v[12:15], v[192:195], v[124:127], v[12:15]
    v_and_b32 v229, s55, v199
    v_add_f32 v216, v216, v218
    v_mfma_f32_16x16x32_bf16 v[16:19], v[192:195], v[96:99], v[16:19]
    ds_read_b64_tr_b16 v[200:201], v233 offset:24576
    v_mfma_f32_16x16x32_bf16 v[20:23], v[192:195], v[100:103], v[20:23]
    v_add_f32 v220, v220, v222
    v_add_f32 v224, v224, v226
    v_mfma_f32_16x16x32_bf16 v[24:27], v[192:195], v[104:107], v[24:27]
    s_waitcnt lgkmcnt(1)
    ds_read_b64_tr_b16 v[202:203], v233 offset:25088
    v_mfma_f32_16x16x32_bf16 v[28:31], v[192:195], v[108:111], v[28:31]
    v_add_f32 v228, v228, v230
    v_add_f32 v217, v217, v219
    v_mfma_f32_16x16x32_bf16 v[32:35], v[196:199], v[144:147], v[32:35]
    ds_read_b64_tr_b16 v[204:205], v233 offset:28672
    v_mfma_f32_16x16x32_bf16 v[36:39], v[196:199], v[148:151], v[36:39]
    v_add_f32 v221, v221, v223
    v_add_f32 v225, v225, v227
    v_mfma_f32_16x16x32_bf16 v[40:43], v[196:199], v[152:155], v[40:43]
    ds_read_b64_tr_b16 v[206:207], v233 offset:29184
    v_mfma_f32_16x16x32_bf16 v[44:47], v[196:199], v[156:159], v[44:47]
    v_add_f32 v229, v229, v231
    v_cvt_pk_bf16_f32 v208, v216, v217
    v_mfma_f32_16x16x32_bf16 v[48:51], v[196:199], v[128:131], v[48:51]
    v_cvt_pk_bf16_f32 v209, v220, v221
    v_cvt_pk_bf16_f32 v210, v224, v225
    v_mfma_f32_16x16x32_bf16 v[52:55], v[196:199], v[132:135], v[52:55]
    v_cvt_pk_bf16_f32 v211, v228, v229
    s_waitcnt lgkmcnt(0)
    s_barrier
    v_mfma_f32_16x16x32_bf16 v[56:59], v[196:199], v[136:139], v[56:59]
    ds_read_b64_tr_b16 v[192:193], v233 offset:32768
    v_mfma_f32_16x16x32_bf16 v[60:63], v[196:199], v[140:143], v[60:63]
    ds_read_b64_tr_b16 v[194:195], v233 offset:33280
    v_mfma_f32_16x16x32_bf16 v[64:67], v[208:211], v[176:179], v[64:67]
    ds_read_b64_tr_b16 v[196:197], v233 offset:36864
    v_mfma_f32_16x16x32_bf16 v[68:71], v[208:211], v[180:183], v[68:71]
    ds_read_b64_tr_b16 v[198:199], v233 offset:37376
    v_mfma_f32_16x16x32_bf16 v[72:75], v[208:211], v[184:187], v[72:75]
    v_lshlrev_b32 v218, 16, v200
    v_lshlrev_b32 v222, 16, v201
    v_mfma_f32_16x16x32_bf16 v[76:79], v[208:211], v[188:191], v[76:79]
    v_lshlrev_b32 v226, 16, v202
    v_lshlrev_b32 v230, 16, v203
    v_mfma_f32_16x16x32_bf16 v[80:83], v[208:211], v[160:163], v[80:83]
    v_and_b32 v219, s55, v200
    v_and_b32 v223, s55, v201
    v_mfma_f32_16x16x32_bf16 v[84:87], v[208:211], v[164:167], v[84:87]
    ds_read_b128 v[112:115], v235 offset:2688
    v_mfma_f32_16x16x32_bf16 v[88:91], v[208:211], v[168:171], v[88:91]
    v_and_b32 v227, s55, v202
    v_and_b32 v231, s55, v203
    v_mfma_f32_16x16x32_bf16 v[92:95], v[208:211], v[172:175], v[92:95]
    v_lshlrev_b32 v216, 16, v204
    v_lshlrev_b32 v220, 16, v205
    v_mfma_f32_16x16x32_bf16 v[0:3], v[200:203], v[116:119], v[0:3]
    v_lshlrev_b32 v224, 16, v206
    v_lshlrev_b32 v228, 16, v207
    v_mfma_f32_16x16x32_bf16 v[4:7], v[200:203], v[120:123], v[4:7]
    v_and_b32 v217, s55, v204
    v_and_b32 v221, s55, v205
    v_mfma_f32_16x16x32_bf16 v[8:11], v[200:203], v[124:127], v[8:11]
    v_and_b32 v225, s55, v206
    v_and_b32 v229, s55, v207
    v_mfma_f32_16x16x32_bf16 v[12:15], v[200:203], v[96:99], v[12:15]
    v_add_f32 v216, v216, v218
    v_add_f32 v220, v220, v222
    v_mfma_f32_16x16x32_bf16 v[16:19], v[200:203], v[100:103], v[16:19]
    v_add_f32 v224, v224, v226
    v_add_f32 v228, v228, v230
    v_mfma_f32_16x16x32_bf16 v[20:23], v[200:203], v[104:107], v[20:23]
    v_add_f32 v217, v217, v219
    v_add_f32 v221, v221, v223
    v_mfma_f32_16x16x32_bf16 v[24:27], v[200:203], v[108:111], v[24:27]
    s_waitcnt lgkmcnt(0)
    ds_read_b128 v[144:147], v235 offset:21696
    v_mfma_f32_16x16x32_bf16 v[28:31], v[200:203], v[112:115], v[28:31]
    v_add_f32 v225, v225, v227
    v_add_f32 v229, v229, v231
    v_mfma_f32_16x16x32_bf16 v[32:35], v[204:207], v[148:151], v[32:35]
    v_cvt_pk_bf16_f32 v212, v216, v217
    v_cvt_pk_bf16_f32 v213, v220, v221
    v_mfma_f32_16x16x32_bf16 v[36:39], v[204:207], v[152:155], v[36:39]
    v_cvt_pk_bf16_f32 v214, v224, v225
    v_cvt_pk_bf16_f32 v215, v228, v229
    v_mfma_f32_16x16x32_bf16 v[40:43], v[204:207], v[156:159], v[40:43]
    v_lshlrev_b32 v218, 16, v192
    v_lshlrev_b32 v222, 16, v193
    v_mfma_f32_16x16x32_bf16 v[44:47], v[204:207], v[128:131], v[44:47]
    v_lshlrev_b32 v226, 16, v194
    v_lshlrev_b32 v230, 16, v195
    v_mfma_f32_16x16x32_bf16 v[48:51], v[204:207], v[132:135], v[48:51]
    v_and_b32 v219, s55, v192
    v_and_b32 v223, s55, v193
    v_mfma_f32_16x16x32_bf16 v[52:55], v[204:207], v[136:139], v[52:55]
    v_and_b32 v227, s55, v194
    v_and_b32 v231, s55, v195
    v_mfma_f32_16x16x32_bf16 v[56:59], v[204:207], v[140:143], v[56:59]
    s_waitcnt lgkmcnt(0)
    v_lshlrev_b32 v216, 16, v196
    v_lshlrev_b32 v220, 16, v197
    v_mfma_f32_16x16x32_bf16 v[60:63], v[204:207], v[144:147], v[60:63]
    v_lshlrev_b32 v224, 16, v198
    v_lshlrev_b32 v228, 16, v199
    v_mfma_f32_16x16x32_bf16 v[64:67], v[212:215], v[180:183], v[64:67]
    v_and_b32 v217, s55, v196
    v_and_b32 v221, s55, v197
    s_barrier
    ds_read_b128 v[176:179], v235 offset:40704
    v_mfma_f32_16x16x32_bf16 v[68:71], v[212:215], v[184:187], v[68:71]
    v_and_b32 v225, s55, v198
    v_and_b32 v229, s55, v199
    v_mfma_f32_16x16x32_bf16 v[72:75], v[212:215], v[188:191], v[72:75]
    v_add_f32 v216, v216, v218
    v_add_f32 v220, v220, v222
    v_mfma_f32_16x16x32_bf16 v[76:79], v[212:215], v[160:163], v[76:79]
    v_add_f32 v224, v224, v226
    v_add_f32 v228, v228, v230
    v_mfma_f32_16x16x32_bf16 v[80:83], v[212:215], v[164:167], v[80:83]
    v_add_f32 v217, v217, v219
    v_add_f32 v221, v221, v223
    ds_read_b64_tr_b16 v[200:201], v233 offset:40960
    v_mfma_f32_16x16x32_bf16 v[84:87], v[212:215], v[168:171], v[84:87]
    v_add_f32 v225, v225, v227
    v_add_f32 v229, v229, v231
    ds_read_b64_tr_b16 v[202:203], v233 offset:41472
    v_mfma_f32_16x16x32_bf16 v[88:91], v[212:215], v[172:175], v[88:91]
    s_waitcnt lgkmcnt(2)
    v_cvt_pk_bf16_f32 v208, v216, v217
    v_cvt_pk_bf16_f32 v209, v220, v221
    v_mfma_f32_16x16x32_bf16 v[92:95], v[212:215], v[176:179], v[92:95]
    v_cvt_pk_bf16_f32 v210, v224, v225
    v_cvt_pk_bf16_f32 v211, v228, v229
    v_mfma_f32_16x16x32_bf16 v[0:3], v[192:195], v[120:123], v[0:3]
    ds_read_b32 v244, v245
    v_mfma_f32_16x16x32_bf16 v[32:35], v[196:199], v[152:155], v[32:35]
    ds_read_b128 v[116:119], v235 offset:2816
    v_mfma_f32_16x16x32_bf16 v[64:67], v[208:211], v[184:187], v[64:67]
    s_waitcnt lgkmcnt(2)
    ds_read_b128 v[180:183], v235 offset:40832
    v_mfma_f32_16x16x32_bf16 v[0:3], v[200:203], v[124:127], v[0:3]
    ds_read_b128 v[148:151], v235 offset:21824
    v_mfma_f32_16x16x32_bf16 v[64:67], v[200:203], v[188:191], v[64:67]
    ds_read_b128 v[120:123], v235 offset:2944
    v_mfma_f32_16x16x32_bf16 v[4:7], v[192:195], v[124:127], v[4:7]
    ds_read_b128 v[184:187], v235 offset:40960
    v_mfma_f32_16x16x32_bf16 v[36:39], v[196:199], v[156:159], v[36:39]
    s_nop 1
    v_mfma_f32_16x16x32_bf16 v[68:71], v[208:211], v[188:191], v[68:71]
    s_nop 1
    v_mfma_f32_16x16x32_bf16 v[4:7], v[200:203], v[96:99], v[4:7]
    v_add_f32 v32, v32, v64
    v_add_f32 v0, v0, v64
    v_mfma_f32_16x16x32_bf16 v[68:71], v[200:203], v[160:163], v[68:71]
    v_add_f32 v33, v33, v65
    v_add_f32 v1, v1, v65
    v_mfma_f32_16x16x32_bf16 v[8:11], v[192:195], v[96:99], v[8:11]
    v_add_f32 v34, v34, v66
    v_add_f32 v2, v2, v66
    v_mfma_f32_16x16x32_bf16 v[40:43], v[196:199], v[128:131], v[40:43]
    v_add_f32 v35, v35, v67
    v_add_f32 v3, v3, v67
    v_mfma_f32_16x16x32_bf16 v[72:75], v[208:211], v[160:163], v[72:75]
    v_cvt_pk_bf16_f32 v64, v0, v1
    v_cvt_pk_bf16_f32 v66, v32, v33
    v_mfma_f32_16x16x32_bf16 v[8:11], v[200:203], v[100:103], v[8:11]
    v_cvt_pk_bf16_f32 v65, v2, v3
    v_cvt_pk_bf16_f32 v67, v34, v35
    v_mfma_f32_16x16x32_bf16 v[72:75], v[200:203], v[164:167], v[72:75]
    buffer_store_dwordx4 v[64:67], v241, s[28:31], s88 offen nt
    v_add_f32 v36, v36, v68
    v_mfma_f32_16x16x32_bf16 v[12:15], v[192:195], v[100:103], v[12:15]
    v_add_f32 v4, v4, v68
    v_add_f32 v37, v37, v69
    v_mfma_f32_16x16x32_bf16 v[44:47], v[196:199], v[132:135], v[44:47]
    v_add_f32 v5, v5, v69
    v_add_f32 v38, v38, v70
    v_mfma_f32_16x16x32_bf16 v[76:79], v[208:211], v[164:167], v[76:79]
    v_add_f32 v6, v6, v70
    v_add_f32 v39, v39, v71
    v_mfma_f32_16x16x32_bf16 v[12:15], v[200:203], v[104:107], v[12:15]
    v_add_f32 v7, v7, v71
    v_cvt_pk_bf16_f32 v68, v4, v5
    v_mfma_f32_16x16x32_bf16 v[76:79], v[200:203], v[168:171], v[76:79]
    v_cvt_pk_bf16_f32 v70, v36, v37
    v_cvt_pk_bf16_f32 v69, v6, v7
    v_mfma_f32_16x16x32_bf16 v[16:19], v[192:195], v[104:107], v[16:19]
    v_cvt_pk_bf16_f32 v71, v38, v39
    buffer_store_dwordx4 v[68:71], v241, s[28:31], s89 offen nt
    v_mfma_f32_16x16x32_bf16 v[48:51], v[196:199], v[136:139], v[48:51]
    v_add_f32 v40, v40, v72
    v_add_f32 v8, v8, v72
    v_mfma_f32_16x16x32_bf16 v[80:83], v[208:211], v[168:171], v[80:83]
    v_add_f32 v41, v41, v73
    v_add_f32 v9, v9, v73
    v_mfma_f32_16x16x32_bf16 v[16:19], v[200:203], v[108:111], v[16:19]
    v_add_f32 v42, v42, v74
    v_add_f32 v10, v10, v74
    v_mfma_f32_16x16x32_bf16 v[80:83], v[200:203], v[172:175], v[80:83]
    v_add_f32 v43, v43, v75
    v_add_f32 v11, v11, v75
    v_mfma_f32_16x16x32_bf16 v[20:23], v[192:195], v[108:111], v[20:23]
    v_cvt_pk_bf16_f32 v72, v8, v9
    v_cvt_pk_bf16_f32 v74, v40, v41
    v_mfma_f32_16x16x32_bf16 v[52:55], v[196:199], v[140:143], v[52:55]
    v_cvt_pk_bf16_f32 v73, v10, v11
    v_cvt_pk_bf16_f32 v75, v42, v43
    v_mfma_f32_16x16x32_bf16 v[84:87], v[208:211], v[172:175], v[84:87]
    buffer_store_dwordx4 v[72:75], v241, s[28:31], s90 offen nt
    v_add_f32 v44, v44, v76
    v_mfma_f32_16x16x32_bf16 v[20:23], v[200:203], v[112:115], v[20:23]
    v_add_f32 v12, v12, v76
    v_add_f32 v45, v45, v77
    v_mfma_f32_16x16x32_bf16 v[84:87], v[200:203], v[176:179], v[84:87]
    v_add_f32 v13, v13, v77
    v_add_f32 v46, v46, v78
    v_mfma_f32_16x16x32_bf16 v[24:27], v[192:195], v[112:115], v[24:27]
    v_add_f32 v14, v14, v78
    v_add_f32 v47, v47, v79
    v_mfma_f32_16x16x32_bf16 v[56:59], v[196:199], v[144:147], v[56:59]
    v_add_f32 v15, v15, v79
    v_cvt_pk_bf16_f32 v76, v12, v13
    v_mfma_f32_16x16x32_bf16 v[88:91], v[208:211], v[176:179], v[88:91]
    s_waitcnt lgkmcnt(0)
    v_cvt_pk_bf16_f32 v78, v44, v45
    v_mfma_f32_16x16x32_bf16 v[24:27], v[200:203], v[116:119], v[24:27]
    v_cvt_pk_bf16_f32 v77, v14, v15
    v_cvt_pk_bf16_f32 v79, v46, v47
    v_mfma_f32_16x16x32_bf16 v[88:91], v[200:203], v[180:183], v[88:91]
    buffer_store_dwordx4 v[76:79], v241, s[28:31], s91 offen nt
    v_add_f32 v48, v48, v80
    v_mfma_f32_16x16x32_bf16 v[28:31], v[192:195], v[116:119], v[28:31]
    v_add_f32 v16, v16, v80
    v_add_f32 v49, v49, v81
    v_mfma_f32_16x16x32_bf16 v[60:63], v[196:199], v[148:151], v[60:63]
    v_add_f32 v17, v17, v81
    v_add_f32 v50, v50, v82
    v_mfma_f32_16x16x32_bf16 v[92:95], v[208:211], v[180:183], v[92:95]
    v_add_f32 v18, v18, v82
    v_add_f32 v51, v51, v83
    v_mfma_f32_16x16x32_bf16 v[28:31], v[200:203], v[120:123], v[28:31]
    v_add_f32 v19, v19, v83
    v_cvt_pk_bf16_f32 v80, v16, v17
    v_mfma_f32_16x16x32_bf16 v[92:95], v[200:203], v[184:187], v[92:95]
    v_cvt_pk_bf16_f32 v82, v48, v49
    v_cvt_pk_bf16_f32 v81, v18, v19
    s_waitcnt lgkmcnt(0)
    v_readfirstlane_b32 s50, v244
    v_mov_b32 v240, 1
    v_cvt_pk_bf16_f32 v83, v50, v51
    buffer_store_dwordx4 v[80:83], v241, s[28:31], s92 offen nt
    v_add_f32 v52, v52, v84
    v_add_f32 v20, v20, v84
    v_add_f32 v53, v53, v85
    v_add_f32 v21, v21, v85
    v_add_f32 v54, v54, v86
    v_add_f32 v22, v22, v86
    v_add_f32 v55, v55, v87
    v_add_f32 v23, v23, v87
    v_cvt_pk_bf16_f32 v84, v20, v21
    v_cvt_pk_bf16_f32 v86, v52, v53
    v_cvt_pk_bf16_f32 v85, v22, v23
    v_cvt_pk_bf16_f32 v87, v54, v55
    buffer_store_dwordx4 v[84:87], v241, s[28:31], s93 offen nt
    v_pk_add_f32 v[56:57], v[56:57], v[88:89]
    v_pk_add_f32 v[24:25], v[24:25], v[88:89]
    v_pk_add_f32 v[58:59], v[58:59], v[90:91]
    v_pk_add_f32 v[26:27], v[26:27], v[90:91]
    v_cvt_pk_bf16_f32 v88, v24, v25
    v_cvt_pk_bf16_f32 v90, v56, v57
    v_cvt_pk_bf16_f32 v89, v26, v27
    v_cvt_pk_bf16_f32 v91, v58, v59
    buffer_store_dwordx4 v[88:91], v241, s[28:31], s94 offen nt
    v_pk_add_f32 v[60:61], v[60:61], v[92:93]
    v_pk_add_f32 v[28:29], v[28:29], v[92:93]
    v_pk_add_f32 v[62:63], v[62:63], v[94:95]
    v_pk_add_f32 v[30:31], v[30:31], v[94:95]
    v_cvt_pk_bf16_f32 v92, v28, v29
    v_cvt_pk_bf16_f32 v94, v60, v61
    v_cvt_pk_bf16_f32 v93, v30, v31
    v_cvt_pk_bf16_f32 v95, v62, v63
    buffer_store_dwordx4 v[92:95], v241, s[28:31], s95 offen nt
    v_lshlrev_b32 v238, 4, v232
    s_lshl_b32 s45, s36, 11
    s_add_u32 s45, s45, 81664
    v_add_u32 v238, s45, v238
    s_cmp_eq_u32 s37, 0
    s_cbranch_scc1 L_own0
    s_cmp_eq_u32 s37, 1
    s_cbranch_scc1 L_own1
    s_cmp_eq_u32 s37, 2
    s_cbranch_scc1 L_own2
    s_cmp_eq_u32 s37, 3
    s_cbranch_scc1 L_own3
    s_cmp_eq_u32 s37, 4
    s_cbranch_scc1 L_own4
    s_cmp_eq_u32 s37, 5
    s_cbranch_scc1 L_own5
    s_cmp_eq_u32 s37, 6
    s_cbranch_scc1 L_own6
    ds_write_b128 v238, v[28:31]
    ds_write_b128 v238, v[60:63] offset:1024
L_ownd:
    s_cmp_eq_u32 s50, 0
    s_cbranch_scc1 L_sslow
    s_mov_b64 exec, 0xff
    s_waitcnt vmcnt(0) lgkmcnt(0)
    buffer_store_dword v240, v247, s[28:31], s56 offen
    s_mov_b64 exec, -1
L_fin:
    s_mov_b32 s45, 0x4038aa3b
    s_mov_b32 s46, 0xbfb8aa3b
    s_mov_b32 s47, 0xbeaaaaab
    s_mov_b32 s48, 0x3c800000
L_w0:
    buffer_load_dword v237, v246, s[28:31], 0 offen sc1
    s_waitcnt vmcnt(0)
    v_cmp_eq_u32 vcc, 0, v237
    s_nop 0
    s_bfe_u32 s51, vcc_lo, 0x80008
    s_and_b32 s51, s51, vcc_lo
    s_cbranch_scc1 L_w0
    s_and_b32 s53, vcc_lo, 0xff
    s_cbranch_scc1 L_chk
L_go:
    buffer_load_dwordx4 v[160:163], v243, s[28:31], s80 offen sc1
    buffer_load_dwordx4 v[164:167], v243, s[28:31], s82 offen sc1
    buffer_load_dwordx4 v[168:171], v243, s[28:31], s84 offen sc1
    buffer_load_dwordx4 v[172:175], v252, s[28:31], s86 offen sc1
    ds_read_b128 v[216:219], v253
    ds_read_b128 v[220:223], v253 offset:1024
    s_waitcnt vmcnt(3)
    v_lshlrev_b32 v176, 16, v160
    v_and_b32 v177, s55, v160
    v_lshlrev_b32 v178, 16, v161
    v_and_b32 v179, s55, v161
    v_lshlrev_b32 v180, 16, v162
    v_and_b32 v181, s55, v162
    v_lshlrev_b32 v182, 16, v163
    v_and_b32 v183, s55, v163
    s_waitcnt lgkmcnt(0)
    v_pk_add_f32 v[176:177], v[176:177], v[216:217]
    v_pk_add_f32 v[178:179], v[178:179], v[218:219]
    v_pk_add_f32 v[180:181], v[180:181], v[220:221]
    v_pk_add_f32 v[182:183], v[182:183], v[222:223]
    s_waitcnt vmcnt(2)
    v_lshlrev_b32 v184, 16, v164
    v_and_b32 v185, s55, v164
    v_lshlrev_b32 v186, 16, v165
    v_and_b32 v187, s55, v165
    v_lshlrev_b32 v188, 16, v166
    v_and_b32 v189, s55, v166
    v_lshlrev_b32 v190, 16, v167
    v_and_b32 v191, s55, v167
    v_pk_add_f32 v[176:177], v[176:177], v[184:185]
    v_pk_add_f32 v[178:179], v[178:179], v[186:187]
    v_pk_add_f32 v[180:181], v[180:181], v[188:189]
    v_pk_add_f32 v[182:183], v[182:183], v[190:191]
    s_waitcnt vmcnt(1)
    v_lshlrev_b32 v192, 16, v168
    v_and_b32 v193, s55, v168
    v_lshlrev_b32 v194, 16, v169
    v_and_b32 v195, s55, v169
    v_lshlrev_b32 v196, 16, v170
    v_and_b32 v197, s55, v170
    v_lshlrev_b32 v198, 16, v171
    v_and_b32 v199, s55, v171
    v_pk_add_f32 v[176:177], v[176:177], v[192:193]
    v_pk_add_f32 v[178:179], v[178:179], v[194:195]
    v_pk_add_f32 v[180:181], v[180:181], v[196:197]
    v_pk_add_f32 v[182:183], v[182:183], v[198:199]
    s_waitcnt vmcnt(0)
    v_lshlrev_b32 v200, 16, v172
    v_and_b32 v201, s55, v172
    v_lshlrev_b32 v202, 16, v173
    v_and_b32 v203, s55, v173
    v_lshlrev_b32 v204, 16, v174
    v_and_b32 v205, s55, v174
    v_lshlrev_b32 v206, 16, v175
    v_and_b32 v207, s55, v175
    v_pk_add_f32 v[176:177], v[176:177], v[200:201]
    v_pk_add_f32 v[178:179], v[178:179], v[202:203]
    v_pk_add_f32 v[180:181], v[180:181], v[204:205]
    v_pk_add_f32 v[182:183], v[182:183], v[206:207]
    s_nop 1
    v_permlane32_swap_b32 v176, v180
    v_permlane32_swap_b32 v177, v181
    v_permlane32_swap_b32 v178, v182
    v_permlane32_swap_b32 v179, v183
    v_mul_f32 v208, s45, v176
    v_mul_f32 v209, s45, v177
    v_mul_f32 v210, s45, v178
    v_mul_f32 v211, s45, v179
    v_exp_f32 v208, v208
    v_mul_f32 v180, s46, v180
    v_exp_f32 v209, v209
    v_mul_f32 v181, s46, v181
    v_exp_f32 v210, v210
    v_mul_f32 v182, s46, v182
    v_exp_f32 v211, v211
    v_mul_f32 v183, s46, v183
    v_exp_f32 v180, v180
    v_mul_f32 v212, v176, v176
    v_exp_f32 v181, v181
    v_mul_f32 v213, v177, v177
    v_exp_f32 v182, v182
    v_mul_f32 v214, v178, v178
    v_exp_f32 v183, v183
    v_mul_f32 v215, v179, v179
    v_add_f32 v208, 1.0, v208
    v_add_f32 v180, 1.0, v180
    v_add_f32 v209, 1.0, v209
    v_add_f32 v181, 1.0, v181
    v_add_f32 v210, 1.0, v210
    v_add_f32 v182, 1.0, v182
    v_add_f32 v211, 1.0, v211
    v_add_f32 v183, 1.0, v183
    v_rcp_f32 v208, v208
    v_rcp_f32 v180, v180
    v_rcp_f32 v209, v209
    v_rcp_f32 v181, v181
    v_rcp_f32 v210, v210
    v_rcp_f32 v182, v182
    v_rcp_f32 v211, v211
    v_rcp_f32 v183, v183
    v_mul_f32 v212, s47, v212
    v_cmp_gt_f32 s[88:89], s48, abs(v176)
    v_mul_f32 v213, s47, v213
    v_cmp_gt_f32 s[90:91], s48, abs(v177)
    v_mul_f32 v214, s47, v214
    v_cmp_gt_f32 s[92:93], s48, abs(v178)
    v_mul_f32 v215, s47, v215
    v_cmp_gt_f32 s[94:95], s48, abs(v179)
    v_fma_f32 v208, v208, -2.0, 1.0
    v_fma_f32 v212, v212, v176, v176
    v_fma_f32 v209, v209, -2.0, 1.0
    v_fma_f32 v213, v213, v177, v177
    v_fma_f32 v210, v210, -2.0, 1.0
    v_fma_f32 v214, v214, v178, v178
    v_fma_f32 v211, v211, -2.0, 1.0
    v_fma_f32 v215, v215, v179, v179
    v_cndmask_b32 v208, v208, v212, s[88:89]
    v_cndmask_b32 v209, v209, v213, s[90:91]
    v_cndmask_b32 v210, v210, v214, s[92:93]
    v_cndmask_b32 v211, v211, v215, s[94:95]
    v_mul_f32 v208, v208, v180
    v_mul_f32 v209, v209, v181
    v_mul_f32 v210, v210, v182
    v_mul_f32 v211, v211, v183
    v_cvt_pk_bf16_f32 v212, v208, v209
    v_cvt_pk_bf16_f32 v213, v210, v211
    buffer_store_dwordx2 v[212:213], v242, s[24:27], 0 offen
    s_endpgm
L_chk:
    s_cmp_lg_u32 s50, 1
    s_cbranch_scc1 L_go
    s_mov_b32 s50, 2
    s_branch L_resend
L_sslow:
    v_mov_b32 v246, v236
L_resend:
    s_waitcnt vmcnt(0) lgkmcnt(0)
    buffer_store_dwordx4 v[64:67], v241, s[28:31], s88 offen sc1
    buffer_store_dwordx4 v[68:71], v241, s[28:31], s89 offen sc1
    buffer_store_dwordx4 v[72:75], v241, s[28:31], s90 offen sc1
    buffer_store_dwordx4 v[76:79], v241, s[28:31], s91 offen sc1
    buffer_store_dwordx4 v[80:83], v241, s[28:31], s92 offen sc1
    buffer_store_dwordx4 v[84:87], v241, s[28:31], s93 offen sc1
    buffer_store_dwordx4 v[88:91], v241, s[28:31], s94 offen sc1
    buffer_store_dwordx4 v[92:95], v241, s[28:31], s95 offen sc1
    s_mov_b64 exec, 0xff
    s_waitcnt vmcnt(0)
    buffer_store_dword v240, v247, s[28:31], s49 offen sc1
    s_mov_b64 exec, -1
    s_branch L_fin
L_own0:
    ds_write_b128 v238, v[0:3]
    ds_write_b128 v238, v[32:35] offset:1024
    s_branch L_ownd
L_own1:
    ds_write_b128 v238, v[4:7]
    ds_write_b128 v238, v[36:39] offset:1024
    s_branch L_ownd
L_own2:
    ds_write_b128 v238, v[8:11]
    ds_write_b128 v238, v[40:43] offset:1024
    s_branch L_ownd
L_own3:
    ds_write_b128 v238, v[12:15]
    ds_write_b128 v238, v[44:47] offset:1024
    s_branch L_ownd
L_own4:
    ds_write_b128 v238, v[16:19]
    ds_write_b128 v238, v[48:51] offset:1024
    s_branch L_ownd
L_own5:
    ds_write_b128 v238, v[20:23]
    ds_write_b128 v238, v[52:55] offset:1024
    s_branch L_ownd
L_own6:
    ds_write_b128 v238, v[24:27]
    ds_write_b128 v238, v[56:59] offset:1024
    s_branch L_ownd
L_hfin:
    ds_read_b32 v244, v245
    s_mov_b32 s50, 2
    v_mov_b32 v241, 0x7ff00000
    v_mov_b32 v247, 0x7ff00000
    s_waitcnt lgkmcnt(0)
    v_cmp_eq_u32 vcc, 0, v244
    s_nop 1
    v_cndmask_b32 v246, v246, v236, vcc
    s_branch L_fin
L_lrest:
    s_lshl_b32 s45, s40, 1
    s_or_b32 s45, s45, s43
    s_lshl_b32 s45, s45, 13
    v_and_b32 v17, 7, v232
    v_lshlrev_b32 v17, 10, v17
    v_add_u32 v17, s45, v17
    v_lshrrev_b32 v18, 3, v232
    s_waitcnt vmcnt(1)
    s_barrier
    s_add_u32 m0, s52, 73472
    s_mov_b32 s51, 1048576
    buffer_load_dwordx4 v248, s[20:23], s51 offen lds
    buffer_load_dwordx4 v249, s[20:23], s51 offen offset:2048 lds
    s_add_u32 m0, s52, 77568
    s_mov_b32 s51, 1310720
    buffer_load_dwordx4 v248, s[20:23], s51 offen lds
    buffer_load_dwordx4 v249, s[20:23], s51 offen offset:2048 lds
    s_add_u32 m0, s52, 81664
    s_mov_b32 s51, 1572864
    buffer_load_dwordx4 v248, s[20:23], s51 offen lds
    buffer_load_dwordx4 v249, s[20:23], s51 offen offset:2048 lds
    s_add_u32 m0, s52, 85760
    s_mov_b32 s51, 1835008
    buffer_load_dwordx4 v248, s[20:23], s51 offen lds
    buffer_load_dwordx4 v249, s[20:23], s51 offen offset:2048 lds
    s_add_u32 m0, s52, 89856
    s_mov_b32 s51, 2097152
    buffer_load_dwordx4 v248, s[20:23], s51 offen lds
    buffer_load_dwordx4 v249, s[20:23], s51 offen offset:2048 lds
    s_add_u32 m0, s52, 93952
    s_mov_b32 s51, 2359296
    buffer_load_dwordx4 v248, s[20:23], s51 offen lds
    buffer_load_dwordx4 v249, s[20:23], s51 offen offset:2048 lds
    s_waitcnt vmcnt(8)
    s_barrier
    s_add_u32 m0, s52, 98048
    s_mov_b32 s51, 2621440
    buffer_load_dwordx4 v248, s[20:23], s51 offen lds
    buffer_load_dwordx4 v249, s[20:23], s51 offen offset:2048 lds
    s_add_u32 m0, s52, 102144
    s_mov_b32 s51, 2883584
    buffer_load_dwordx4 v248, s[20:23], s51 offen lds
    buffer_load_dwordx4 v249, s[20:23], s51 offen offset:2048 lds
    s_add_u32 m0, s52, 106240
    s_mov_b32 s51, 3145728
    buffer_load_dwordx4 v248, s[20:23], s51 offen lds
    buffer_load_dwordx4 v249, s[20:23], s51 offen offset:2048 lds
    s_add_u32 m0, s52, 110336
    s_mov_b32 s51, 3407872
    buffer_load_dwordx4 v248, s[20:23], s51 offen lds
    buffer_load_dwordx4 v249, s[20:23], s51 offen offset:2048 lds
    s_waitcnt vmcnt(12)
    s_barrier
    s_add_u32 m0, s52, 114432
    s_mov_b32 s51, 3670016
    buffer_load_dwordx4 v248, s[20:23], s51 offen lds
    buffer_load_dwordx4 v249, s[20:23], s51 offen offset:2048 lds
    s_add_u32 m0, s52, 118528
    s_mov_b32 s51, 3932160
    buffer_load_dwordx4 v248, s[20:23], s51 offen lds
    buffer_load_dwordx4 v249, s[20:23], s51 offen offset:2048 lds
    s_add_u32 m0, s52, 122624
    s_mov_b32 s51, 4194304
    buffer_load_dwordx4 v248, s[20:23], s51 offen lds
    buffer_load_dwordx4 v249, s[20:23], s51 offen offset:2048 lds
    s_add_u32 m0, s52, 126720
    s_mov_b32 s51, 4456448
    buffer_load_dwordx4 v248, s[20:23], s51 offen lds
    buffer_load_dwordx4 v249, s[20:23], s51 offen offset:2048 lds
    s_waitcnt vmcnt(16)
    s_barrier
    s_add_u32 m0, s52, 130816
    s_mov_b32 s51, 4718592
    buffer_load_dwordx4 v248, s[20:23], s51 offen lds
    buffer_load_dwordx4 v249, s[20:23], s51 offen offset:2048 lds
    s_add_u32 m0, s52, 134912
    s_mov_b32 s51, 4980736
    buffer_load_dwordx4 v248, s[20:23], s51 offen lds
    buffer_load_dwordx4 v249, s[20:23], s51 offen offset:2048 lds
    v_and_b32 v12, 31, v10
    v_lshl_add_u32 v12, v12, 18, v11
    v_lshrrev_b32 v14, 5, v10
    v_lshl_add_u32 v12, v14, 15, v12
    buffer_load_dword v15, v12, s[60:63], 0 offen
    v_add_u32 v10, 16, v10
    v_and_b32 v12, 31, v10
    v_lshl_add_u32 v12, v12, 18, v11
    v_lshrrev_b32 v14, 5, v10
    v_lshl_add_u32 v12, v14, 15, v12
    s_mov_b32 exec_lo, 0xffffff
    s_mov_b32 exec_hi, 0x0
    buffer_load_dword v15, v12, s[60:63], 0 offen
    s_mov_b64 exec, -1
    v_add_u32 v10, 6, v10
    s_waitcnt vmcnt(18)
    s_barrier
    s_lshl_b32 s44, s39, 1
    s_or_b32 s44, s44, s40
    s_lshl_b32 s44, s44, 1
    s_or_b32 s44, s44, s41
    s_lshl_b32 s44, s44, 2
    s_or_b32 s44, s44, s38
    s_mov_b32 s28, s12
    s_mov_b32 s29, s13
    s_mov_b32 s30, 8650752
    s_mov_b32 s31, 0x20000
    s_mov_b32 s24, s8
    s_mov_b32 s25, s9
    s_mov_b32 s26, 1024000
    s_mov_b32 s27, 0x20000
    s_and_b32 s48, s36, 3
    s_waitcnt vmcnt(14)
    s_barrier
    s_lshr_b32 s47, s36, 2
    s_lshl_b32 s45, s44, 3
    s_add_u32 s45, s45, s37
    s_lshl_b32 s46, s45, 15
    v_and_b32 v243, 31, v232
    v_lshlrev_b32 v243, 4, v243
    v_lshrrev_b32 v237, 5, v232
    v_lshl_add_u32 v243, v237, 12, v243
    v_add_u32 v243, s46, v243
    s_lshl_b32 s46, s48, 1
    s_add_u32 s46, s46, s47
    s_lshl_b32 s46, s46, 9
    v_add_u32 v243, s46, v243
    s_lshl_b32 s45, s45, 10
    s_add_u32 s45, s45, 8388608
    s_waitcnt vmcnt(10)
    s_barrier
    v_and_b32 v246, 7, v232
    v_lshlrev_b32 v246, 2, v246
    v_add_u32 v246, s45, v246
    s_lshl_b32 s46, s48, 5
    s_add_u32 s46, s46, 512
    v_add_u32 v236, s46, v246
    s_lshl_b32 s46, s48, 7
    v_add_u32 v246, s46, v246
    v_and_b32 v237, 8, v232
    v_cmp_ne_u32 s[58:59], 0, v237
    v_mov_b32 v245, 57024
    s_nop 0
    v_cndmask_b32 v246, v246, v236, s[58:59]
    v_and_b32 v237, 15, v232
    v_bfe_u32 v238, v232, 4, 1
    s_lshl_b32 s45, s41, 7
    s_waitcnt vmcnt(6)
    s_barrier
    s_add_u32 m0, s52, 139008
    s_mov_b32 s51, 5242880
    buffer_load_dwordx4 v248, s[20:23], s51 offen lds
    buffer_load_dwordx4 v249, s[20:23], s51 offen offset:2048 lds
    s_add_u32 m0, s52, 143104
    s_mov_b32 s51, 5505024
    buffer_load_dwordx4 v248, s[20:23], s51 offen lds
    buffer_load_dwordx4 v249, s[20:23], s51 offen offset:2048 lds
    s_add_u32 m0, s52, 147200
    s_mov_b32 s51, 5767168
    buffer_load_dwordx4 v248, s[20:23], s51 offen lds
    buffer_load_dwordx4 v249, s[20:23], s51 offen offset:2048 lds
    s_add_u32 m0, s52, 151296
    s_mov_b32 s51, 6029312
    buffer_load_dwordx4 v248, s[20:23], s51 offen lds
    buffer_load_dwordx4 v249, s[20:23], s51 offen offset:2048 lds
    s_waitcnt vmcnt(10)
    s_barrier
    s_add_u32 m0, s52, 155392
    s_mov_b32 s51, 6291456
    buffer_load_dwordx4 v248, s[20:23], s51 offen lds
    buffer_load_dwordx4 v249, s[20:23], s51 offen offset:2048 lds
    s_add_u32 m0, s52, 159488
    s_mov_b32 s51, 6553600
    buffer_load_dwordx4 v248, s[20:23], s51 offen lds
    buffer_load_dwordx4 v249, s[20:23], s51 offen offset:2048 lds
    s_add_u32 m0, s52, 57088
    s_mov_b32 s51, 6815744
    buffer_load_dwordx4 v248, s[20:23], s51 offen lds
    buffer_load_dwordx4 v249, s[20:23], s51 offen offset:2048 lds
    s_add_u32 m0, s52, 61184
    s_mov_b32 s51, 7077888
    buffer_load_dwordx4 v248, s[20:23], s51 offen lds
    buffer_load_dwordx4 v249, s[20:23], s51 offen offset:2048 lds
    s_waitcnt vmcnt(12)
    s_barrier
    s_add_u32 m0, s52, 65280
    s_mov_b32 s51, 7340032
    buffer_load_dwordx4 v248, s[20:23], s51 offen lds
    buffer_load_dwordx4 v249, s[20:23], s51 offen offset:2048 lds
    s_add_u32 m0, s52, 69376
    s_mov_b32 s51, 7602176
    buffer_load_dwordx4 v248, s[20:23], s51 offen lds
    buffer_load_dwordx4 v249, s[20:23], s51 offen offset:2048 lds
    s_add_u32 m0, s52, 73472
    s_mov_b32 s51, 7864320
    buffer_load_dwordx4 v248, s[20:23], s51 offen lds
    buffer_load_dwordx4 v249, s[20:23], s51 offen offset:2048 lds
    s_waitcnt vmcnt(14)
    s_barrier
    s_add_u32 m0, s52, 81664
    s_mov_b32 s51, 32768
    buffer_load_dwordx4 v248, s[20:23], s51 offen lds
    buffer_load_dwordx4 v249, s[20:23], s51 offen offset:2048 lds
    s_add_u32 m0, s52, 85760
    s_mov_b32 s51, 294912
    buffer_load_dwordx4 v248, s[20:23], s51 offen lds
    buffer_load_dwordx4 v249, s[20:23], s51 offen offset:2048 lds
    s_add_u32 m0, s52, 89856
    s_mov_b32 s51, 557056
    buffer_load_dwordx4 v248, s[20:23], s51 offen lds
    buffer_load_dwordx4 v249, s[20:23], s51 offen offset:2048 lds
    s_add_u32 m0, s52, 93952
    s_mov_b32 s51, 819200
    buffer_load_dwordx4 v248, s[20:23], s51 offen lds
    buffer_load_dwordx4 v249, s[20:23], s51 offen offset:2048 lds
    s_waitcnt vmcnt(18)
    s_barrier
    s_add_u32 m0, s52, 98048
    s_mov_b32 s51, 1081344
    buffer_load_dwordx4 v248, s[20:23], s51 offen lds
    buffer_load_dwordx4 v249, s[20:23], s51 offen offset:2048 lds
    s_add_u32 m0, s52, 102144
    s_mov_b32 s51, 1343488
    buffer_load_dwordx4 v248, s[20:23], s51 offen lds
    buffer_load_dwordx4 v249, s[20:23], s51 offen offset:2048 lds
    s_add_u32 m0, s52, 106240
    s_mov_b32 s51, 1605632
    buffer_load_dwordx4 v248, s[20:23], s51 offen lds
    buffer_load_dwordx4 v249, s[20:23], s51 offen offset:2048 lds
    s_add_u32 m0, s52, 110336
    s_mov_b32 s51, 1867776
    buffer_load_dwordx4 v248, s[20:23], s51 offen lds
    buffer_load_dwordx4 v249, s[20:23], s51 offen offset:2048 lds
    s_waitcnt vmcnt(22)
    s_barrier
    v_and_b32 v12, 31, v10
    v_lshl_add_u32 v12, v12, 18, v11
    v_lshrrev_b32 v14, 5, v10
    v_lshl_add_u32 v12, v14, 15, v12
    buffer_load_dword v15, v12, s[60:63], 0 offen
    v_add_u32 v10, 16, v10
    v_and_b32 v12, 31, v10
    v_lshl_add_u32 v12, v12, 18, v11
    v_lshrrev_b32 v14, 5, v10
    v_lshl_add_u32 v12, v14, 15, v12
    s_mov_b32 exec_lo, 0xffffff
    s_mov_b32 exec_hi, 0x0
    buffer_load_dword v15, v12, s[60:63], 0 offen
    s_mov_b64 exec, -1
    v_add_u32 v10, 6, v10
    s_waitcnt vmcnt(20)
    s_barrier
    s_add_u32 s45, s45, s37
    v_lshl_add_u32 v239, v237, 3, s45
    v_lshlrev_b32 v242, 11, v239
    v_lshrrev_b32 v240, 5, v232
    v_lshl_add_u32 v242, v240, 10, v242
    v_lshl_add_u32 v242, v238, 3, v242
    s_lshl_b32 s45, s40, 9
    s_add_u32 s45, s45, s54
    s_lshl_b32 s46, s38, 7
    s_add_u32 s45, s45, s46
    s_lshl_b32 s46, s48, 5
    s_add_u32 s45, s45, s46
    s_lshl_b32 s46, s47, 4
    s_add_u32 s45, s45, s46
    v_add_u32 v242, s45, v242
    s_waitcnt vmcnt(18)
    s_barrier
    v_mov_b32 v237, 0x7ffff000
    s_movk_i32 s46, 250
    v_cmp_gt_u32 s[58:59], s46, v239
    s_mov_b32 s80, 0
    s_mov_b32 s82, 8192
    s_mov_b32 s84, 16384
    s_mov_b32 s86, 24576
    v_cndmask_b32 v242, v237, v242, s[58:59]
    v_lshrrev_b32 v238, 5, v232
    v_cmp_eq_u32 s[58:59], s43, v238
    v_and_b32 v253, 31, v232
    v_lshlrev_b32 v253, 4, v253
    s_lshl_b32 s45, s48, 11
    s_lshl_b32 s46, s47, 9
    s_add_u32 s45, s45, s46
    s_waitcnt vmcnt(14)
    s_barrier
    s_add_u32 m0, s52, 114432
    s_mov_b32 s51, 2129920
    buffer_load_dwordx4 v248, s[20:23], s51 offen lds
    buffer_load_dwordx4 v249, s[20:23], s51 offen offset:2048 lds
    s_add_u32 m0, s52, 118528
    s_mov_b32 s51, 2392064
    buffer_load_dwordx4 v248, s[20:23], s51 offen lds
    buffer_load_dwordx4 v249, s[20:23], s51 offen offset:2048 lds
    s_add_u32 m0, s52, 122624
    s_mov_b32 s51, 2654208
    buffer_load_dwordx4 v248, s[20:23], s51 offen lds
    buffer_load_dwordx4 v249, s[20:23], s51 offen offset:2048 lds
    s_add_u32 m0, s52, 126720
    s_mov_b32 s51, 2916352
    buffer_load_dwordx4 v248, s[20:23], s51 offen lds
    buffer_load_dwordx4 v249, s[20:23], s51 offen offset:2048 lds
    s_waitcnt vmcnt(18)
    s_barrier
    s_add_u32 m0, s52, 130816
    s_mov_b32 s51, 3178496
    buffer_load_dwordx4 v248, s[20:23], s51 offen lds
    buffer_load_dwordx4 v249, s[20:23], s51 offen offset:2048 lds
    s_add_u32 m0, s52, 134912
    s_mov_b32 s51, 3440640
    buffer_load_dwordx4 v248, s[20:23], s51 offen lds
    buffer_load_dwordx4 v249, s[20:23], s51 offen offset:2048 lds
    s_add_u32 m0, s52, 139008
    s_mov_b32 s51, 3702784
    buffer_load_dwordx4 v248, s[20:23], s51 offen lds
    buffer_load_dwordx4 v249, s[20:23], s51 offen offset:2048 lds
    s_add_u32 m0, s52, 143104
    s_mov_b32 s51, 3964928
    buffer_load_dwordx4 v248, s[20:23], s51 offen lds
    buffer_load_dwordx4 v249, s[20:23], s51 offen offset:2048 lds
    s_waitcnt vmcnt(22)
    s_barrier
    s_add_u32 m0, s52, 147200
    s_mov_b32 s51, 4227072
    buffer_load_dwordx4 v248, s[20:23], s51 offen lds
    buffer_load_dwordx4 v249, s[20:23], s51 offen offset:2048 lds
    s_add_u32 m0, s52, 151296
    s_mov_b32 s51, 4489216
    buffer_load_dwordx4 v248, s[20:23], s51 offen lds
    buffer_load_dwordx4 v249, s[20:23], s51 offen offset:2048 lds
    s_add_u32 m0, s52, 155392
    s_mov_b32 s51, 4751360
    buffer_load_dwordx4 v248, s[20:23], s51 offen lds
    buffer_load_dwordx4 v249, s[20:23], s51 offen offset:2048 lds
    s_add_u32 m0, s52, 159488
    s_mov_b32 s51, 5013504
    buffer_load_dwordx4 v248, s[20:23], s51 offen lds
    buffer_load_dwordx4 v249, s[20:23], s51 offen offset:2048 lds
    s_waitcnt vmcnt(26)
    s_barrier
    s_add_u32 m0, s52, 57088
    s_mov_b32 s51, 5275648
    buffer_load_dwordx4 v248, s[20:23], s51 offen lds
    buffer_load_dwordx4 v249, s[20:23], s51 offen offset:2048 lds
    s_add_u32 m0, s52, 61184
    s_mov_b32 s51, 5537792
    buffer_load_dwordx4 v248, s[20:23], s51 offen lds
    buffer_load_dwordx4 v249, s[20:23], s51 offen offset:2048 lds
    s_add_u32 m0, s52, 65280
    s_mov_b32 s51, 5799936
    buffer_load_dwordx4 v248, s[20:23], s51 offen lds
    buffer_load_dwordx4 v249, s[20:23], s51 offen offset:2048 lds
    s_add_u32 m0, s52, 69376
    s_mov_b32 s51, 6062080
    buffer_load_dwordx4 v248, s[20:23], s51 offen lds
    buffer_load_dwordx4 v249, s[20:23], s51 offen offset:2048 lds
    s_waitcnt vmcnt(28)
    s_barrier
    s_add_u32 m0, s52, 73472
    s_mov_b32 s51, 6324224
    buffer_load_dwordx4 v248, s[20:23], s51 offen lds
    buffer_load_dwordx4 v249, s[20:23], s51 offen offset:2048 lds
    s_add_u32 m0, s52, 77568
    s_mov_b32 s51, 6586368
    buffer_load_dwordx4 v248, s[20:23], s51 offen lds
    buffer_load_dwordx4 v249, s[20:23], s51 offen offset:2048 lds
    s_add_u32 m0, s52, 81664
    s_mov_b32 s51, 6848512
    buffer_load_dwordx4 v248, s[20:23], s51 offen lds
    buffer_load_dwordx4 v249, s[20:23], s51 offen offset:2048 lds
    s_add_u32 m0, s52, 85760
    s_mov_b32 s51, 7110656
    buffer_load_dwordx4 v248, s[20:23], s51 offen lds
    buffer_load_dwordx4 v249, s[20:23], s51 offen offset:2048 lds
    s_waitcnt vmcnt(32)
    s_barrier
    s_add_u32 m0, s52, 89856
    s_mov_b32 s51, 7372800
    buffer_load_dwordx4 v248, s[20:23], s51 offen lds
    buffer_load_dwordx4 v249, s[20:23], s51 offen offset:2048 lds
    s_add_u32 m0, s52, 93952
    s_mov_b32 s51, 7634944
    buffer_load_dwordx4 v248, s[20:23], s51 offen lds
    buffer_load_dwordx4 v249, s[20:23], s51 offen offset:2048 lds
    s_add_u32 m0, s52, 98048
    s_mov_b32 s51, 7897088
    buffer_load_dwordx4 v248, s[20:23], s51 offen lds
    buffer_load_dwordx4 v249, s[20:23], s51 offen offset:2048 lds
    s_waitcnt vmcnt(34)
    s_barrier
    s_add_u32 s45, s45, 81664
    v_add_u32 v253, s45, v253
    v_cndmask_b32 v252, v243, v237, s[58:59]
    v_cndmask_b32 v253, v237, v253, s[58:59]
    s_add_u32 s45, s42, 1
    s_and_b32 s45, s45, 3
    s_lshl_b32 s80, s45, 13
    s_add_u32 s45, s42, 2
    s_and_b32 s45, s45, 3
    s_lshl_b32 s82, s45, 13
    s_add_u32 s45, s42, 3
    s_and_b32 s45, s45, 3
    s_lshl_b32 s84, s45, 13
    s_add_u32 s45, s42, 4
    s_and_b32 s45, s45, 3
    s_lshl_b32 s86, s45, 13
    s_waitcnt vmcnt(30)
    s_barrier
    s_lshl_b32 s45, s44, 3
    s_add_u32 s45, s45, s37
    s_lshl_b32 s45, s45, 1
    s_add_u32 s45, s45, s57
    s_lshl_b32 s45, s45, 14
    v_lshlrev_b32 v19, 7, v232
    v_add_u32 v19, s45, v19
    s_mov_b64 exec, 1
    buffer_load_dword v15, v242, s[24:27], 0 offen
    s_mov_b64 exec, -1
    v_add_u32 v13, 0, v19
    v_bfe_u32 v14, v13, 12, 3
    v_cmp_ne_u32 vcc, s37, v14
    s_mov_b64 exec, vcc
    buffer_load_dword v15, v13, s[28:31], 0 offen sc1
    s_mov_b64 exec, -1
    v_add_u32 v13, 8192, v19
    v_bfe_u32 v14, v13, 12, 3
    v_cmp_ne_u32 vcc, s37, v14
    s_mov_b64 exec, vcc
    buffer_load_dword v15, v13, s[28:31], 0 offen sc1
    s_mov_b64 exec, -1
    s_waitcnt vmcnt(29)
    s_barrier
    s_waitcnt vmcnt(25)
    s_barrier
    s_waitcnt vmcnt(21)
    s_barrier
    s_waitcnt vmcnt(17)
    s_barrier
    s_waitcnt vmcnt(13)
    s_barrier
    s_waitcnt vmcnt(9)
    s_barrier
    s_waitcnt vmcnt(5)
    s_barrier
    s_waitcnt vmcnt(3)
    s_barrier
    s_branch L_hfin
L_helper2:
    s_waitcnt lgkmcnt(0)
    s_cmp_eq_u32 s36, 5
    s_cbranch_scc0 L_service
    s_mov_b32 s53, 0
    s_barrier
    s_mov_b32 s53, 1
    s_mov_b64 vcc, -1
    s_branch L_pad78
L_padret78:
    s_barrier
    s_add_u32 s53, s53, 1
    s_branch L_pad331
L_padret331:
    s_barrier
    s_add_u32 s53, s53, 1
    s_branch L_pad576
L_padret576:
    s_barrier
    s_add_u32 s53, s53, 1
L_aux:
    s_barrier
    s_add_u32 s53, s53, 1
L_aux2:
    s_cmp_lt_u32 s53, 31
    s_cbranch_scc1 L_aux
    s_branch L_hfin
L_service:
    s_cmp_eq_u32 s41, 1
    s_cselect_b32 s53, 1, 1
L_sb1:
    s_barrier
    s_sub_u32 s53, s53, 1
    s_cmp_lg_u32 s53, 0
    s_cbranch_scc1 L_sb1
    s_mov_b32 s32, s10
    s_mov_b32 s33, s11
    s_mov_b32 s34, 256
    s_mov_b32 s35, 0x20000
    s_lshl_b32 s45, s44, 13
    s_add_u32 s45, s45, 8388608
    v_lshrrev_b32 v6, 3, v232
    v_lshlrev_b32 v6, 10, v6
    v_add_u32 v6, s45, v6
    v_and_b32 v7, 7, v232
    v_lshl_add_u32 v7, v7, 4, v6
    v_bfe_u32 v8, v232, 1, 2
    v_lshl_add_u32 v6, v8, 7, v6
    v_and_b32 v8, 1, v232
    v_lshl_add_u32 v6, v8, 4, v6
    s_lshl_b32 s46, s44, 3
    v_mov_b32 v12, s46
    v_mov_b32 v0, 0
    v_mov_b32 v1, 0
    v_mov_b32 v2, 0
    v_mov_b32 v3, 0
    s_getreg_b32 s50, hwreg(HW_REG_XCC_ID)
    s_and_b32 s50, s50, 15
    s_or_b32 s50, s50, 16
    v_mov_b32 v9, s50
    s_cmp_eq_u32 s41, 1
    s_cselect_b32 s53, 4, 4
L_sb2:
    s_barrier
    s_sub_u32 s53, s53, 1
    s_cmp_lg_u32 s53, 0
    s_cbranch_scc1 L_sb2
    s_cmp_lg_u32 s37, 0
    s_cbranch_scc1 L_nl1
    buffer_store_dwordx4 v[0:3], v6, s[28:31], 0 offen sc1
    buffer_store_dwordx4 v[0:3], v7, s[28:31], 0 offen offset:512 sc1
L_nl1:
    s_cmp_eq_u32 s41, 1
    s_cselect_b32 s53, 5, 5
L_sb3:
    s_barrier
    s_sub_u32 s53, s53, 1
    s_cmp_lg_u32 s53, 0
    s_cbranch_scc1 L_sb3
    s_cmp_lg_u32 s37, 0
    s_cbranch_scc1 L_nl2
    s_waitcnt vmcnt(0)
    s_mov_b64 exec, 1
    buffer_store_dword v9, v12, s[32:35], 0 offen sc1
    s_mov_b64 exec, -1
L_nl2:
    s_cmp_eq_u32 s41, 1
    s_cselect_b32 s53, 8, 8
L_sb4:
    s_barrier
    s_sub_u32 s53, s53, 1
    s_cmp_lg_u32 s53, 0
    s_cbranch_scc1 L_sb4
    buffer_load_dword v4, v12, s[32:35], 0 offen sc1
    s_cmp_eq_u32 s41, 1
    s_cselect_b32 s53, 3, 3
L_sb5:
    s_barrier
    s_sub_u32 s53, s53, 1
    s_cmp_lg_u32 s53, 0
    s_cbranch_scc1 L_sb5
    s_branch L_p1c
L_p1:
    buffer_load_dword v4, v12, s[32:35], 0 offen sc1
L_p1c:
    s_waitcnt vmcnt(0)
    v_cmp_eq_u32 vcc, 0, v4
    s_cbranch_vccnz L_p1
    v_cmp_eq_u32 vcc, s50, v4
    v_mov_b32 v5, 0
    v_mov_b32 v6, 1
    v_cndmask_b32 v4, v5, v6, vcc
    ds_write_b32 v245, v4
    s_waitcnt lgkmcnt(0)
    s_cmp_eq_u32 s41, 1
    s_cselect_b32 s53, 10, 10
L_sb6:
    s_barrier
    s_sub_u32 s53, s53, 1
    s_cmp_lg_u32 s53, 0
    s_cbranch_scc1 L_sb6
    s_branch L_hfin
L_end:
    s_endpgm
L_codeend:
.section .rodata,"a"
.p2align 6
.amdhsa_kernel standalone__autoregressive_conv_wavernn__speech_kernel
  .amdhsa_next_free_vgpr 256
  .amdhsa_next_free_sgpr 100
  .amdhsa_accum_offset 256
  .amdhsa_group_segment_fixed_size 0
  .amdhsa_kernarg_size 40
  .amdhsa_user_sgpr_count 2
  .amdhsa_user_sgpr_kernarg_segment_ptr 1
  .amdhsa_system_sgpr_workgroup_id_x 1
.end_amdhsa_kernel
```
